```python
import torch

def _softmax(x, axis=-1):
    return torch.softmax(x, dim=axis)
def _gelu(x):
    return torch.nn.functional.gelu(x, approximate="tanh")
def _silu(x):
    return torch.nn.functional.silu(x)
def _sigmoid(x):
    return torch.sigmoid(x)
def _layernorm(x, axis=-1, eps=1e-5):
    m = x.mean(dim=axis, keepdim=True)
    v = x.var(dim=axis, keepdim=True, unbiased=False)
    return (x - m) / torch.sqrt(v + eps)
def _scatter_add(tgt, idx, src, axis=0):
    return tgt.clone().index_add_(axis, idx, src)
def _segment_sum(src, seg, n):
    out = torch.zeros((n,) + src.shape[1:], dtype=src.dtype)
    return out.index_add_(0, seg, src)
def _pad(x, pw):
    flat = tuple(v for pair in reversed(pw) for v in pair)
    return torch.nn.functional.pad(x, flat)

kernel_name = 'concat_heads__gqa_block_cached__gqa_block_cached__near_ridge'

def setup_inputs():

    _w = (lambda a: (lambda t: t.to(torch.bfloat16) if t.is_floating_point() else t)(torch.as_tensor(a)))
    def _A_setup():
        B, Sq, D = 8, 112, 512
        Hq, Hkv, Sk, Dh = 32, 32, 512, 128
        assert Hq % Hkv == 0, (Hq, Hkv)
        return {
            "x": _w((lambda *s: torch.randn(*s, dtype=torch.bfloat16) * 0.8)(B, Sq, D)),
            "k_cache": _w((lambda *s: torch.randn(*s, dtype=torch.bfloat16) * 0.8)(B, Hkv, Sk, Dh)),
            "v_cache": _w((lambda *s: torch.randn(*s, dtype=torch.bfloat16) * 0.05)(B, Hkv, Sk, Dh)),
            "wq": _w((lambda *s: torch.randn(*s, dtype=torch.bfloat16) * 0.8)(D, Hq * Dh) * (D ** -0.5)),
            "wo": _w((lambda *s: torch.randn(*s, dtype=torch.bfloat16) * 0.05)(Hq * Dh, D) * ((Hq * Dh) ** -0.5)),
        }
    _A_in = _A_setup()

    def _B_setup():
        B, Sq, D = 8, 112, 512
        Hq, Hkv, Sk, Dh = 32, 32, 512, 128
        assert Hq % Hkv == 0, (Hq, Hkv)
        return {
            "x": _w((lambda *s: torch.randn(*s, dtype=torch.bfloat16) * 0.8)(B, Sq, D)),
            "k_cache": _w((lambda *s: torch.randn(*s, dtype=torch.bfloat16) * 0.8)(B, Hkv, Sk, Dh)),
            "v_cache": _w((lambda *s: torch.randn(*s, dtype=torch.bfloat16) * 0.05)(B, Hkv, Sk, Dh)),
            "wq": _w((lambda *s: torch.randn(*s, dtype=torch.bfloat16) * 0.8)(D, Hq * Dh) * (D ** -0.5)),
            "wo": _w((lambda *s: torch.randn(*s, dtype=torch.bfloat16) * 0.05)(Hq * Dh, D) * ((Hq * Dh) ** -0.5)),
        }
    _B_in = _B_setup()

    return {
        "A_x": _A_in["x"],
        "A_k_cache": _A_in["k_cache"],
        "A_v_cache": _A_in["v_cache"],
        "A_wq": _A_in["wq"],
        "A_wo": _A_in["wo"],
        "B_x": _B_in["x"],
        "B_k_cache": _B_in["k_cache"],
        "B_v_cache": _B_in["v_cache"],
        "B_wq": _B_in["wq"],
        "B_wo": _B_in["wo"],
    }

def reference(A_x, A_k_cache, A_v_cache, A_wq, A_wo, B_x, B_k_cache, B_v_cache, B_wq, B_wo):
    def _A_ref(x, k_cache, v_cache, wq, wo):
        B, Sq, D = x.shape
        Hq, Dh = 32, 128
        Hkv = k_cache.shape[1]
        rep = Hq // Hkv
        q = (lambda x, *d: x.permute(*d))((x @ wq).reshape(B, Sq, Hq, Dh), 0, 2, 1, 3)
        k = (lambda x, n, axis: torch.repeat_interleave(x, n, dim=axis))(k_cache, rep, axis=1)
        v = (lambda x, n, axis: torch.repeat_interleave(x, n, dim=axis))(v_cache, rep, axis=1)
        scores = torch.einsum("bhqd,bhkd->bhqk", q, k) * (Dh ** -0.5)
        p = _softmax(scores, axis=-1)
        o = torch.einsum("bhqk,bhkd->bhqd", p, v)
        return (lambda x, *d: x.permute(*d))(o, 0, 2, 1, 3).reshape(B, Sq, Hq * Dh) @ wo

    def _B_ref(x, k_cache, v_cache, wq, wo):
        B, Sq, D = x.shape
        Hq, Dh = 32, 128
        Hkv = k_cache.shape[1]
        rep = Hq // Hkv
        q = (lambda x, *d: x.permute(*d))((x @ wq).reshape(B, Sq, Hq, Dh), 0, 2, 1, 3)
        k = (lambda x, n, axis: torch.repeat_interleave(x, n, dim=axis))(k_cache, rep, axis=1)
        v = (lambda x, n, axis: torch.repeat_interleave(x, n, dim=axis))(v_cache, rep, axis=1)
        scores = torch.einsum("bhqd,bhkd->bhqk", q, k) * (Dh ** -0.5)
        p = _softmax(scores, axis=-1)
        o = torch.einsum("bhqk,bhkd->bhqd", p, v)
        return (lambda x, *d: x.permute(*d))(o, 0, 2, 1, 3).reshape(B, Sq, Hq * Dh) @ wo

    a = _A_ref(A_x, A_k_cache, A_v_cache, A_wq, A_wo)
    b = _B_ref(B_x, B_k_cache, B_v_cache, B_wq, B_wo)
    return torch.concatenate([a, b], axis=-1)
```

```asm
; @launch grid=(256,1,1) block=(512,1,1) lds=163840
.amdgcn_target "amdgcn-amd-amdhsa--gfx950"
.text
.globl concat_heads__gqa_block_cached__gqa_block_cached__near_ridge_kernel
.p2align 8
.type concat_heads__gqa_block_cached__gqa_block_cached__near_ridge_kernel,@function
concat_heads__gqa_block_cached__gqa_block_cached__near_ridge_kernel:
    s_cmp_ge_u32 s2, 256
    s_cbranch_scc1 END
    s_load_dwordx8 s[64:71], s[0:1], 0
    s_load_dwordx8 s[76:83], s[0:1], 40
    s_load_dwordx2 s[72:73], s[0:1], 32
    s_load_dwordx2 s[74:75], s[0:1], 72
    s_load_dwordx4 s[84:87], s[0:1], 80
    s_load_dwordx2 s[88:89], s[0:1], 96
    v_readfirstlane_b32 s40, v0
    v_and_b32 v12, 63, v0
    s_lshr_b32 s40, s40, 6
    s_lshr_b32 s41, s40, 2
    s_and_b32 s42, s40, 3
    s_and_b32 s3, s2, 7
    s_lshr_b32 s4, s2, 3
    s_lshr_b32 s63, s3, 2
    s_and_b32 s3, s3, 3
    s_and_b32 s62, s4, 7
    s_lshr_b32 s4, s4, 3
    s_lshl_b32 s61, s3, 2
    s_or_b32 s61, s61, s4
    s_lshl_b32 s90, s61, 1
    s_lshl_b32 s60, s63, 3
    s_or_b32 s60, s60, s62
    v_lshrrev_b32 v16, 4, v12
    v_and_b32 v17, 15, v12
    v_lshrrev_b32 v20, 3, v12
    v_and_b32 v21, 7, v12
    v_lshlrev_b32 v18, 2, v16
    v_xor_b32 v18, v18, v17
    v_lshlrev_b32 v18, 4, v18
    s_lshl_b32 s3, s42, 4
    v_add_u32 v19, s3, v16
    v_lshl_add_u32 v1, v19, 13, v18
    v_add_u32 v13, 31744, v1
    v_add_u32 v14, 63488, v1
    v_add_u32 v15, 95232, v1
    s_and_b32 s4, s40, 1
    s_lshl_b32 s4, s4, 2
    v_or_b32 v19, s4, v16
    v_xor_b32 v19, v19, v21
    v_lshlrev_b32 v19, 4, v19
    s_lshl_b32 s3, s40, 3
    v_add_u32 v2, s3, v20
    v_lshl_add_u32 v2, v2, 10, v19
    s_lshl_b32 s52, s41, 14
    s_lshl_b32 s3, s42, 12
    s_add_u32 s52, s52, s3
    s_lshl_b32 s53, s40, 10
    s_add_u32 s53, s53, 32768
    s_lshl_b32 s54, s41, 14
    s_lshl_b32 s3, s42, 11
    s_add_u32 s54, s54, s3
    s_lshl_b32 s55, s40, 12
    s_mul_i32 s3, s62, 114688
    s_add_u32 s4, s90, s41
    s_lshl_b32 s5, s4, 8
    s_mov_b32 s10, 114688
    s_mov_b32 s11, 0x00020000
    s_sub_u32 s14, 4194304, s5
    s_mov_b32 s15, 0x00020000
    s_lshl_b32 s6, s42, 3
    v_add_u32 v19, s6, v16
    v_lshl_add_u32 v5, v19, 8, v18
    s_and_b32 s6, s42, 1
    s_lshl_b32 s6, s6, 3
    v_or_b32 v18, s6, v16
    v_xor_b32 v18, v18, v17
    v_lshlrev_b32 v18, 4, v18
    v_lshl_add_u32 v3, v19, 8, v18
    v_xor_b32 v4, 64, v3
    s_waitcnt lgkmcnt(0)
    s_cmp_eq_u32 s63, 1
    s_cselect_b64 s[64:65], s[76:77], s[64:65]
    s_cselect_b64 s[70:71], s[82:83], s[70:71]
    s_cselect_b64 s[66:67], s[78:79], s[66:67]
    s_cselect_b64 s[68:69], s[80:81], s[68:69]
    s_cselect_b64 s[72:73], s[74:75], s[72:73]
    s_add_u32 s8, s64, s3
    s_addc_u32 s9, s65, 0
    s_add_u32 s12, s70, s5
    s_addc_u32 s13, s71, 0
    s_add_u32 m0, s52, 0
    s_nop 0
    buffer_load_dwordx4 v1, s[12:15], 0 offen lds
    buffer_load_dwordx4 v13, s[12:15], 0 offen offset:1024 lds
    buffer_load_dwordx4 v14, s[12:15], 0 offen offset:2048 lds
    buffer_load_dwordx4 v15, s[12:15], 0 offen offset:3072 lds
    s_add_u32 m0, s53, 0
    s_nop 0
    buffer_load_dwordx4 v2, s[8:11], 0 offen nt lds
    s_add_u32 m0, s53, 8192
    s_mov_b32 s57, 65536
    buffer_load_dwordx4 v2, s[8:11], s57 offen nt lds
    s_barrier
    s_lshl_b32 s3, s62, 5
    s_add_u32 s3, s3, s4
    s_lshl_b32 s3, s3, 17
    s_add_u32 s16, s66, s3
    s_addc_u32 s17, s67, 0
    s_mov_b32 s18, 131072
    s_mov_b32 s19, 0x00020000
    s_add_u32 s20, s68, s3
    s_addc_u32 s21, s69, 0
    s_mov_b32 s22, 131072
    s_mov_b32 s23, 0x00020000
    s_add_u32 m0, s52, 49152
    s_mov_b32 s56, 524288
    buffer_load_dwordx4 v1, s[12:15], s56 offen lds
    buffer_load_dwordx4 v13, s[12:15], s56 offen offset:1024 lds
    buffer_load_dwordx4 v14, s[12:15], s56 offen offset:2048 lds
    buffer_load_dwordx4 v15, s[12:15], s56 offen offset:3072 lds
    s_add_u32 m0, s53, 49152
    s_mov_b32 s57, 128
    buffer_load_dwordx4 v2, s[8:11], s57 offen nt lds
    s_add_u32 m0, s53, 57344
    s_mov_b32 s57, 65664
    buffer_load_dwordx4 v2, s[8:11], s57 offen nt lds
    s_lshl_b32 s3, s90, 17
    s_add_u32 s24, s72, s3
    s_addc_u32 s25, s73, 0
    s_mov_b32 s26, 262144
    s_mov_b32 s27, 0x00020000
    s_lshl_b32 s3, s60, 4
    s_or_b32 s3, s3, s61
    s_lshl_b32 s3, s3, 17
    s_add_u32 s28, s88, s3
    s_addc_u32 s29, s89, 0
    s_mov_b32 s30, 131072
    s_mov_b32 s31, 0x00020000
    s_lshl_b32 s3, s60, 21
    s_add_u32 s32, s88, s3
    s_addc_u32 s33, s89, 0
    s_mov_b32 s34, 0x200000
    s_mov_b32 s35, 0x00020000
    s_lshl_b32 s3, s60, 13
    s_add_u32 s3, s3, 33554432
    s_add_u32 s44, s88, s3
    s_addc_u32 s45, s89, 0
    s_mov_b32 s46, 8192
    s_mov_b32 s47, 0x00020000
    s_lshl_b32 s3, s60, 4
    s_add_u32 s48, s86, s3
    s_addc_u32 s49, s87, 0
    s_mov_b32 s50, 8
    s_mov_b32 s51, 0x00020000
    s_mov_b32 s36, s84
    s_mov_b32 s37, s85
    s_mov_b32 s38, 1835008
    s_mov_b32 s39, 0x00020000
    s_memrealtime s[4:5]
    v_lshlrev_b32 v84, 4, v0
    v_mov_b32 v82, 0
    v_mov_b32 v83, 0
    s_waitcnt lgkmcnt(0)
    s_or_b32 s5, s5, 0x80000000
    v_mov_b32 v80, s4
    v_mov_b32 v81, s5
    v_and_b32 v18, 1, v16
    v_lshlrev_b32 v18, 2, v18
    v_xor_b32 v18, v18, v21
    v_lshlrev_b32 v18, 4, v18
    s_lshl_b32 s3, s40, 5
    v_add_u32 v19, s3, v20
    v_lshl_add_u32 v6, v19, 10, v18
    v_and_b32 v22, 1, v16
    v_lshrrev_b32 v23, 5, v12
    v_bfe_u32 v28, v12, 2, 2
    v_and_b32 v29, 3, v12
    v_and_b32 v31, 31, v12
    s_lshl_b32 s3, s41, 14
    v_lshl_add_u32 v18, v23, 3, v28
    v_lshlrev_b32 v18, 8, v18
    v_lshl_add_u32 v18, v28, 6, v18
    v_lshl_add_u32 v18, v22, 5, v18
    v_and_b32 v19, 1, v29
    v_lshl_add_u32 v18, v19, 4, v18
    v_lshrrev_b32 v19, 1, v29
    v_lshl_add_u32 v18, v19, 3, v18
    v_add_u32 v7, s3, v18
    v_lshl_add_u32 v18, v23, 2, v28
    v_lshlrev_b32 v10, 8, v18
    v_lshl_add_u32 v10, v28, 6, v10
    v_lshl_add_u32 v10, v22, 5, v10
    v_lshl_add_u32 v10, v29, 3, v10
    s_add_u32 s4, s3, 8192
    v_add_u32 v10, s4, v10
    v_lshlrev_b32 v11, 7, v18
    v_lshrrev_b32 v19, 1, v28
    v_xor_b32 v19, s41, v19
    v_lshl_add_u32 v11, v19, 6, v11
    v_lshl_add_u32 v11, v22, 5, v11
    v_and_b32 v19, 1, v29
    v_lshl_add_u32 v11, v19, 4, v11
    v_lshrrev_b32 v19, 1, v29
    v_lshl_add_u32 v11, v19, 3, v11
    v_add_u32 v11, s3, v11
    v_and_b32 v19, 15, v31
    v_xor_b32 v19, v19, v23
    v_lshlrev_b32 v19, 4, v19
    v_lshl_add_u32 v9, v31, 8, v19
    v_add_u32 v9, s3, v9
    v_bfe_u32 v19, v31, 1, 3
    v_xor_b32 v19, v19, v23
    v_lshlrev_b32 v19, 4, v19
    v_lshl_add_u32 v8, v31, 7, v19
    s_lshl_b32 s4, s42, 12
    s_add_u32 s4, s4, 32768
    v_add_u32 v8, s4, v8
    v_lshlrev_b32 v12, 4, v12
    v_mov_b32 v16, v7
    v_xor_b32 v17, 64, v7
    v_xor_b32 v18, 128, v7
    v_xor_b32 v19, 192, v7
    v_mov_b32 v20, v8
    v_xor_b32 v21, 32, v8
    v_xor_b32 v22, 64, v8
    v_xor_b32 v23, 96, v8
    s_waitcnt vmcnt(6)
    s_barrier
    ds_read_b128 v[240:243], v20 offset:0
    ds_read_b64_tr_b16 v[192:193], v16 offset:0
    ds_read_b64_tr_b16 v[194:195], v16 offset:1024
    ds_read_b64_tr_b16 v[196:197], v17 offset:0
    ds_read_b64_tr_b16 v[198:199], v17 offset:1024
    s_waitcnt lgkmcnt(2)
    v_mfma_f32_32x32x16_bf16 v[128:143], v[192:195], v[240:243], 0
    ds_read_b64_tr_b16 v[200:201], v18 offset:0
    ds_read_b64_tr_b16 v[202:203], v18 offset:1024
    ds_read_b64_tr_b16 v[204:205], v19 offset:0
    ds_read_b64_tr_b16 v[206:207], v19 offset:1024
    ds_read_b128 v[244:247], v21 offset:0
    ds_read_b64_tr_b16 v[208:209], v16 offset:4096
    ds_read_b64_tr_b16 v[210:211], v16 offset:5120
    ds_read_b64_tr_b16 v[212:213], v17 offset:4096
    ds_read_b64_tr_b16 v[214:215], v17 offset:5120
    ds_read_b64_tr_b16 v[216:217], v18 offset:4096
    ds_read_b64_tr_b16 v[218:219], v18 offset:5120
    ds_read_b64_tr_b16 v[220:221], v19 offset:4096
    ds_read_b64_tr_b16 v[222:223], v19 offset:5120
    ds_read_b128 v[248:251], v22 offset:0
    ds_read_b64_tr_b16 v[224:225], v16 offset:8192
    ds_read_b64_tr_b16 v[226:227], v16 offset:9216
    ds_read_b64_tr_b16 v[228:229], v17 offset:8192
    ds_read_b64_tr_b16 v[230:231], v17 offset:9216
    ds_read_b64_tr_b16 v[232:233], v18 offset:8192
    ds_read_b64_tr_b16 v[234:235], v18 offset:9216
    ds_read_b64_tr_b16 v[236:237], v19 offset:8192
    ds_read_b64_tr_b16 v[238:239], v19 offset:9216
    ds_read_b128 v[252:255], v23 offset:0
    ds_read_b64_tr_b16 v[192:193], v16 offset:12288
    ds_read_b64_tr_b16 v[194:195], v16 offset:13312
    s_add_u32 m0, s52, 98304
    s_mov_b32 s56, 1048576
    buffer_load_dwordx4 v1, s[12:15], s56 offen lds
    s_waitcnt lgkmcnt(15)
    v_mfma_f32_32x32x16_bf16 v[144:159], v[196:199], v[240:243], 0
    ds_read_b64_tr_b16 v[196:197], v17 offset:12288
    ds_read_b64_tr_b16 v[198:199], v17 offset:13312
    buffer_load_dwordx4 v13, s[12:15], s56 offen offset:1024 lds
    v_mfma_f32_32x32x16_bf16 v[160:175], v[200:203], v[240:243], 0
    ds_read_b64_tr_b16 v[200:201], v18 offset:12288
    ds_read_b64_tr_b16 v[202:203], v18 offset:13312
    buffer_load_dwordx4 v14, s[12:15], s56 offen offset:2048 lds
    v_mfma_f32_32x32x16_bf16 v[176:191], v[204:207], v[240:243], 0
    ds_read_b64_tr_b16 v[204:205], v19 offset:12288
    ds_read_b64_tr_b16 v[206:207], v19 offset:13312
    buffer_load_dwordx4 v15, s[12:15], s56 offen offset:3072 lds
    v_mfma_f32_32x32x16_bf16 v[128:143], v[208:211], v[244:247], v[128:143]
    s_add_u32 m0, s53, 98304
    s_mov_b32 s57, 256
    buffer_load_dwordx4 v2, s[8:11], s57 offen nt lds
    v_mfma_f32_32x32x16_bf16 v[144:159], v[212:215], v[244:247], v[144:159]
    s_add_u32 m0, s53, 106496
    s_mov_b32 s57, 65792
    buffer_load_dwordx4 v2, s[8:11], s57 offen nt lds
    s_waitcnt lgkmcnt(15)
    v_mfma_f32_32x32x16_bf16 v[160:175], v[216:219], v[244:247], v[160:175]
    v_mfma_f32_32x32x16_bf16 v[176:191], v[220:223], v[244:247], v[176:191]
    s_waitcnt vmcnt(6) lgkmcnt(0)
    s_barrier
    ds_read_b128 v[240:243], v20 offset:49152
    ds_read_b64_tr_b16 v[208:209], v16 offset:49152
    ds_read_b64_tr_b16 v[210:211], v16 offset:50176
    v_mfma_f32_32x32x16_bf16 v[128:143], v[224:227], v[248:251], v[128:143]
    ds_read_b64_tr_b16 v[212:213], v17 offset:49152
    ds_read_b64_tr_b16 v[214:215], v17 offset:50176
    ds_read_b64_tr_b16 v[216:217], v18 offset:49152
    s_add_u32 m0, s52, 0
    s_mov_b32 s56, 1572864
    buffer_load_dwordx4 v1, s[12:15], s56 offen lds
    v_mfma_f32_32x32x16_bf16 v[144:159], v[228:231], v[248:251], v[144:159]
    ds_read_b64_tr_b16 v[218:219], v18 offset:50176
    ds_read_b64_tr_b16 v[220:221], v19 offset:49152
    ds_read_b64_tr_b16 v[222:223], v19 offset:50176
    buffer_load_dwordx4 v13, s[12:15], s56 offen offset:1024 lds
    v_mfma_f32_32x32x16_bf16 v[160:175], v[232:235], v[248:251], v[160:175]
    ds_read_b128 v[244:247], v21 offset:49152
    ds_read_b64_tr_b16 v[224:225], v16 offset:53248
    ds_read_b64_tr_b16 v[226:227], v16 offset:54272
    buffer_load_dwordx4 v14, s[12:15], s56 offen offset:2048 lds
    v_mfma_f32_32x32x16_bf16 v[176:191], v[236:239], v[248:251], v[176:191]
    ds_read_b64_tr_b16 v[228:229], v17 offset:53248
    ds_read_b64_tr_b16 v[230:231], v17 offset:54272
    ds_read_b64_tr_b16 v[232:233], v18 offset:53248
    buffer_load_dwordx4 v15, s[12:15], s56 offen offset:3072 lds
    v_mfma_f32_32x32x16_bf16 v[128:143], v[192:195], v[252:255], v[128:143]
    ds_read_b64_tr_b16 v[234:235], v18 offset:54272
    ds_read_b64_tr_b16 v[236:237], v19 offset:53248
    ds_read_b64_tr_b16 v[238:239], v19 offset:54272
    s_add_u32 m0, s53, 0
    s_mov_b32 s57, 384
    buffer_load_dwordx4 v2, s[8:11], s57 offen nt lds
    v_mfma_f32_32x32x16_bf16 v[144:159], v[196:199], v[252:255], v[144:159]
    ds_read_b128 v[248:251], v22 offset:49152
    ds_read_b64_tr_b16 v[192:193], v16 offset:57344
    ds_read_b64_tr_b16 v[194:195], v16 offset:58368
    s_add_u32 m0, s53, 8192
    s_mov_b32 s57, 65920
    buffer_load_dwordx4 v2, s[8:11], s57 offen nt lds
    v_mfma_f32_32x32x16_bf16 v[160:175], v[200:203], v[252:255], v[160:175]
    ds_read_b64_tr_b16 v[196:197], v17 offset:57344
    ds_read_b64_tr_b16 v[198:199], v17 offset:58368
    ds_read_b64_tr_b16 v[200:201], v18 offset:57344
    v_add_u32 v24, 98304, v16
    v_mfma_f32_32x32x16_bf16 v[176:191], v[204:207], v[252:255], v[176:191]
    ds_read_b64_tr_b16 v[202:203], v18 offset:58368
    ds_read_b64_tr_b16 v[204:205], v19 offset:57344
    ds_read_b64_tr_b16 v[206:207], v19 offset:58368
    s_lshl_b32 s3, s62, 15
    s_lshl_b32 s4, s40, 12
    s_add_u32 s3, s3, s4
    v_lshlrev_b32 v88, 2, v12
    buffer_load_dword v89, v88, s[24:27], s3 offen
    v_add_u32 v25, 98304, v17
    s_waitcnt lgkmcnt(15)
    v_mfma_f32_32x32x16_bf16 v[128:143], v[208:211], v[240:243], v[128:143]
    ds_read_b128 v[252:255], v23 offset:49152
    ds_read_b64_tr_b16 v[208:209], v16 offset:61440
    ds_read_b64_tr_b16 v[210:211], v16 offset:62464
    v_add_u32 v26, 98304, v18
    v_mfma_f32_32x32x16_bf16 v[144:159], v[212:215], v[240:243], v[144:159]
    ds_read_b64_tr_b16 v[212:213], v17 offset:61440
    ds_read_b64_tr_b16 v[214:215], v17 offset:62464
    v_add_u32 v27, 98304, v19
    v_mfma_f32_32x32x16_bf16 v[160:175], v[216:219], v[240:243], v[160:175]
    ds_read_b64_tr_b16 v[216:217], v18 offset:61440
    ds_read_b64_tr_b16 v[218:219], v18 offset:62464
    v_add_u32 v28, 98304, v20
    v_mfma_f32_32x32x16_bf16 v[176:191], v[220:223], v[240:243], v[176:191]
    ds_read_b64_tr_b16 v[220:221], v19 offset:61440
    ds_read_b64_tr_b16 v[222:223], v19 offset:62464
    v_add_u32 v29, 98304, v21
    v_mfma_f32_32x32x16_bf16 v[128:143], v[224:227], v[244:247], v[128:143]
    v_add_u32 v30, 98304, v22
    s_waitcnt lgkmcnt(15)
    v_mfma_f32_32x32x16_bf16 v[144:159], v[228:231], v[244:247], v[144:159]
    v_add_u32 v31, 98304, v23
    v_mfma_f32_32x32x16_bf16 v[160:175], v[232:235], v[244:247], v[160:175]
    v_mfma_f32_32x32x16_bf16 v[176:191], v[236:239], v[244:247], v[176:191]
    s_waitcnt vmcnt(7) lgkmcnt(0)
    s_barrier
    ds_read_b128 v[240:243], v28 offset:0
    ds_read_b64_tr_b16 v[224:225], v24 offset:0
    ds_read_b64_tr_b16 v[226:227], v24 offset:1024
    v_mfma_f32_32x32x16_bf16 v[128:143], v[192:195], v[248:251], v[128:143]
    ds_read_b64_tr_b16 v[228:229], v25 offset:0
    ds_read_b64_tr_b16 v[230:231], v25 offset:1024
    ds_read_b64_tr_b16 v[232:233], v26 offset:0
    s_add_u32 m0, s52, 49152
    s_mov_b32 s56, 2097152
    buffer_load_dwordx4 v1, s[12:15], s56 offen lds
    v_mfma_f32_32x32x16_bf16 v[144:159], v[196:199], v[248:251], v[144:159]
    ds_read_b64_tr_b16 v[234:235], v26 offset:1024
    ds_read_b64_tr_b16 v[236:237], v27 offset:0
    ds_read_b64_tr_b16 v[238:239], v27 offset:1024
    buffer_load_dwordx4 v13, s[12:15], s56 offen offset:1024 lds
    v_mfma_f32_32x32x16_bf16 v[160:175], v[200:203], v[248:251], v[160:175]
    ds_read_b128 v[244:247], v29 offset:0
    ds_read_b64_tr_b16 v[192:193], v24 offset:4096
    ds_read_b64_tr_b16 v[194:195], v24 offset:5120
    buffer_load_dwordx4 v14, s[12:15], s56 offen offset:2048 lds
    v_mfma_f32_32x32x16_bf16 v[176:191], v[204:207], v[248:251], v[176:191]
    ds_read_b64_tr_b16 v[196:197], v25 offset:4096
    ds_read_b64_tr_b16 v[198:199], v25 offset:5120
    ds_read_b64_tr_b16 v[200:201], v26 offset:4096
    buffer_load_dwordx4 v15, s[12:15], s56 offen offset:3072 lds
    v_mfma_f32_32x32x16_bf16 v[128:143], v[208:211], v[252:255], v[128:143]
    ds_read_b64_tr_b16 v[202:203], v26 offset:5120
    ds_read_b64_tr_b16 v[204:205], v27 offset:4096
    ds_read_b64_tr_b16 v[206:207], v27 offset:5120
    s_add_u32 m0, s53, 49152
    s_mov_b32 s57, 512
    buffer_load_dwordx4 v2, s[8:11], s57 offen nt lds
    v_mfma_f32_32x32x16_bf16 v[144:159], v[212:215], v[252:255], v[144:159]
    ds_read_b128 v[248:251], v30 offset:0
    ds_read_b64_tr_b16 v[208:209], v24 offset:8192
    ds_read_b64_tr_b16 v[210:211], v24 offset:9216
    s_add_u32 m0, s53, 57344
    s_mov_b32 s57, 66048
    buffer_load_dwordx4 v2, s[8:11], s57 offen nt lds
    v_mfma_f32_32x32x16_bf16 v[160:175], v[216:219], v[252:255], v[160:175]
    ds_read_b64_tr_b16 v[212:213], v25 offset:8192
    ds_read_b64_tr_b16 v[214:215], v25 offset:9216
    ds_read_b64_tr_b16 v[216:217], v26 offset:8192
    v_mfma_f32_32x32x16_bf16 v[176:191], v[220:223], v[252:255], v[176:191]
    ds_read_b64_tr_b16 v[218:219], v26 offset:9216
    ds_read_b64_tr_b16 v[220:221], v27 offset:8192
    ds_read_b64_tr_b16 v[222:223], v27 offset:9216
    s_waitcnt lgkmcnt(15)
    v_mfma_f32_32x32x16_bf16 v[128:143], v[224:227], v[240:243], v[128:143]
    ds_read_b128 v[252:255], v31 offset:0
    ds_read_b64_tr_b16 v[224:225], v24 offset:12288
    ds_read_b64_tr_b16 v[226:227], v24 offset:13312
    v_mfma_f32_32x32x16_bf16 v[144:159], v[228:231], v[240:243], v[144:159]
    ds_read_b64_tr_b16 v[228:229], v25 offset:12288
    ds_read_b64_tr_b16 v[230:231], v25 offset:13312
    v_mfma_f32_32x32x16_bf16 v[160:175], v[232:235], v[240:243], v[160:175]
    ds_read_b64_tr_b16 v[232:233], v26 offset:12288
    ds_read_b64_tr_b16 v[234:235], v26 offset:13312
    v_mfma_f32_32x32x16_bf16 v[176:191], v[236:239], v[240:243], v[176:191]
    ds_read_b64_tr_b16 v[236:237], v27 offset:12288
    ds_read_b64_tr_b16 v[238:239], v27 offset:13312
    v_mfma_f32_32x32x16_bf16 v[128:143], v[192:195], v[244:247], v[128:143]
    s_waitcnt lgkmcnt(15)
    v_mfma_f32_32x32x16_bf16 v[144:159], v[196:199], v[244:247], v[144:159]
    v_mfma_f32_32x32x16_bf16 v[160:175], v[200:203], v[244:247], v[160:175]
    v_mfma_f32_32x32x16_bf16 v[176:191], v[204:207], v[244:247], v[176:191]
    s_waitcnt vmcnt(7) lgkmcnt(0)
    s_barrier
    ds_read_b128 v[240:243], v20 offset:0
    ds_read_b64_tr_b16 v[192:193], v16 offset:0
    ds_read_b64_tr_b16 v[194:195], v16 offset:1024
    v_mfma_f32_32x32x16_bf16 v[128:143], v[208:211], v[248:251], v[128:143]
    ds_read_b64_tr_b16 v[196:197], v17 offset:0
    ds_read_b64_tr_b16 v[198:199], v17 offset:1024
    ds_read_b64_tr_b16 v[200:201], v18 offset:0
    s_add_u32 m0, s52, 98304
    s_mov_b32 s56, 2621440
    buffer_load_dwordx4 v1, s[12:15], s56 offen lds
    v_mfma_f32_32x32x16_bf16 v[144:159], v[212:215], v[248:251], v[144:159]
    ds_read_b64_tr_b16 v[202:203], v18 offset:1024
    ds_read_b64_tr_b16 v[204:205], v19 offset:0
    ds_read_b64_tr_b16 v[206:207], v19 offset:1024
    buffer_load_dwordx4 v13, s[12:15], s56 offen offset:1024 lds
    v_mfma_f32_32x32x16_bf16 v[160:175], v[216:219], v[248:251], v[160:175]
    ds_read_b128 v[244:247], v21 offset:0
    ds_read_b64_tr_b16 v[208:209], v16 offset:4096
    ds_read_b64_tr_b16 v[210:211], v16 offset:5120
    buffer_load_dwordx4 v14, s[12:15], s56 offen offset:2048 lds
    v_mfma_f32_32x32x16_bf16 v[176:191], v[220:223], v[248:251], v[176:191]
    ds_read_b64_tr_b16 v[212:213], v17 offset:4096
    ds_read_b64_tr_b16 v[214:215], v17 offset:5120
    ds_read_b64_tr_b16 v[216:217], v18 offset:4096
    buffer_load_dwordx4 v15, s[12:15], s56 offen offset:3072 lds
    v_mfma_f32_32x32x16_bf16 v[128:143], v[224:227], v[252:255], v[128:143]
    ds_read_b64_tr_b16 v[218:219], v18 offset:5120
    ds_read_b64_tr_b16 v[220:221], v19 offset:4096
    ds_read_b64_tr_b16 v[222:223], v19 offset:5120
    s_add_u32 m0, s53, 98304
    s_mov_b32 s57, 640
    buffer_load_dwordx4 v2, s[8:11], s57 offen nt lds
    v_mfma_f32_32x32x16_bf16 v[144:159], v[228:231], v[252:255], v[144:159]
    ds_read_b128 v[248:251], v22 offset:0
    ds_read_b64_tr_b16 v[224:225], v16 offset:8192
    ds_read_b64_tr_b16 v[226:227], v16 offset:9216
    s_add_u32 m0, s53, 106496
    s_mov_b32 s57, 66176
    buffer_load_dwordx4 v2, s[8:11], s57 offen nt lds
    v_mfma_f32_32x32x16_bf16 v[160:175], v[232:235], v[252:255], v[160:175]
    ds_read_b64_tr_b16 v[228:229], v17 offset:8192
    ds_read_b64_tr_b16 v[230:231], v17 offset:9216
    ds_read_b64_tr_b16 v[232:233], v18 offset:8192
    v_mfma_f32_32x32x16_bf16 v[176:191], v[236:239], v[252:255], v[176:191]
    ds_read_b64_tr_b16 v[234:235], v18 offset:9216
    ds_read_b64_tr_b16 v[236:237], v19 offset:8192
    ds_read_b64_tr_b16 v[238:239], v19 offset:9216
    s_waitcnt lgkmcnt(15)
    v_mfma_f32_32x32x16_bf16 v[128:143], v[192:195], v[240:243], v[128:143]
    ds_read_b128 v[252:255], v23 offset:0
    ds_read_b64_tr_b16 v[192:193], v16 offset:12288
    ds_read_b64_tr_b16 v[194:195], v16 offset:13312
    v_mfma_f32_32x32x16_bf16 v[144:159], v[196:199], v[240:243], v[144:159]
    ds_read_b64_tr_b16 v[196:197], v17 offset:12288
    ds_read_b64_tr_b16 v[198:199], v17 offset:13312
    v_mfma_f32_32x32x16_bf16 v[160:175], v[200:203], v[240:243], v[160:175]
    ds_read_b64_tr_b16 v[200:201], v18 offset:12288
    ds_read_b64_tr_b16 v[202:203], v18 offset:13312
    v_mfma_f32_32x32x16_bf16 v[176:191], v[204:207], v[240:243], v[176:191]
    ds_read_b64_tr_b16 v[204:205], v19 offset:12288
    ds_read_b64_tr_b16 v[206:207], v19 offset:13312
    v_mfma_f32_32x32x16_bf16 v[128:143], v[208:211], v[244:247], v[128:143]
    s_waitcnt lgkmcnt(15)
    v_mfma_f32_32x32x16_bf16 v[144:159], v[212:215], v[244:247], v[144:159]
    v_mfma_f32_32x32x16_bf16 v[160:175], v[216:219], v[244:247], v[160:175]
    v_mfma_f32_32x32x16_bf16 v[176:191], v[220:223], v[244:247], v[176:191]
    s_waitcnt vmcnt(6) lgkmcnt(0)
    s_barrier
    ds_read_b128 v[240:243], v20 offset:49152
    ds_read_b64_tr_b16 v[208:209], v16 offset:49152
    ds_read_b64_tr_b16 v[210:211], v16 offset:50176
    v_mfma_f32_32x32x16_bf16 v[128:143], v[224:227], v[248:251], v[128:143]
    ds_read_b64_tr_b16 v[212:213], v17 offset:49152
    ds_read_b64_tr_b16 v[214:215], v17 offset:50176
    ds_read_b64_tr_b16 v[216:217], v18 offset:49152
    s_add_u32 m0, s52, 0
    s_mov_b32 s56, 3145728
    buffer_load_dwordx4 v1, s[12:15], s56 offen lds
    v_mfma_f32_32x32x16_bf16 v[144:159], v[228:231], v[248:251], v[144:159]
    ds_read_b64_tr_b16 v[218:219], v18 offset:50176
    ds_read_b64_tr_b16 v[220:221], v19 offset:49152
    ds_read_b64_tr_b16 v[222:223], v19 offset:50176
    buffer_load_dwordx4 v13, s[12:15], s56 offen offset:1024 lds
    v_mfma_f32_32x32x16_bf16 v[160:175], v[232:235], v[248:251], v[160:175]
    ds_read_b128 v[244:247], v21 offset:49152
    ds_read_b64_tr_b16 v[224:225], v16 offset:53248
    ds_read_b64_tr_b16 v[226:227], v16 offset:54272
    buffer_load_dwordx4 v14, s[12:15], s56 offen offset:2048 lds
    v_mfma_f32_32x32x16_bf16 v[176:191], v[236:239], v[248:251], v[176:191]
    ds_read_b64_tr_b16 v[228:229], v17 offset:53248
    ds_read_b64_tr_b16 v[230:231], v17 offset:54272
    ds_read_b64_tr_b16 v[232:233], v18 offset:53248
    buffer_load_dwordx4 v15, s[12:15], s56 offen offset:3072 lds
    v_mfma_f32_32x32x16_bf16 v[128:143], v[192:195], v[252:255], v[128:143]
    ds_read_b64_tr_b16 v[234:235], v18 offset:54272
    ds_read_b64_tr_b16 v[236:237], v19 offset:53248
    ds_read_b64_tr_b16 v[238:239], v19 offset:54272
    s_add_u32 m0, s53, 0
    s_mov_b32 s57, 768
    buffer_load_dwordx4 v2, s[8:11], s57 offen nt lds
    v_mfma_f32_32x32x16_bf16 v[144:159], v[196:199], v[252:255], v[144:159]
    ds_read_b128 v[248:251], v22 offset:49152
    ds_read_b64_tr_b16 v[192:193], v16 offset:57344
    ds_read_b64_tr_b16 v[194:195], v16 offset:58368
    s_add_u32 m0, s53, 8192
    s_mov_b32 s57, 66304
    buffer_load_dwordx4 v2, s[8:11], s57 offen nt lds
    v_mfma_f32_32x32x16_bf16 v[160:175], v[200:203], v[252:255], v[160:175]
    ds_read_b64_tr_b16 v[196:197], v17 offset:57344
    ds_read_b64_tr_b16 v[198:199], v17 offset:58368
    ds_read_b64_tr_b16 v[200:201], v18 offset:57344
    v_mfma_f32_32x32x16_bf16 v[176:191], v[204:207], v[252:255], v[176:191]
    ds_read_b64_tr_b16 v[202:203], v18 offset:58368
    ds_read_b64_tr_b16 v[204:205], v19 offset:57344
    ds_read_b64_tr_b16 v[206:207], v19 offset:58368
    s_waitcnt lgkmcnt(15)
    v_mfma_f32_32x32x16_bf16 v[128:143], v[208:211], v[240:243], v[128:143]
    ds_read_b128 v[252:255], v23 offset:49152
    ds_read_b64_tr_b16 v[208:209], v16 offset:61440
    ds_read_b64_tr_b16 v[210:211], v16 offset:62464
    v_mfma_f32_32x32x16_bf16 v[144:159], v[212:215], v[240:243], v[144:159]
    ds_read_b64_tr_b16 v[212:213], v17 offset:61440
    ds_read_b64_tr_b16 v[214:215], v17 offset:62464
    v_mfma_f32_32x32x16_bf16 v[160:175], v[216:219], v[240:243], v[160:175]
    ds_read_b64_tr_b16 v[216:217], v18 offset:61440
    ds_read_b64_tr_b16 v[218:219], v18 offset:62464
    v_mfma_f32_32x32x16_bf16 v[176:191], v[220:223], v[240:243], v[176:191]
    ds_read_b64_tr_b16 v[220:221], v19 offset:61440
    ds_read_b64_tr_b16 v[222:223], v19 offset:62464
    v_mfma_f32_32x32x16_bf16 v[128:143], v[224:227], v[244:247], v[128:143]
    s_waitcnt lgkmcnt(15)
    v_mfma_f32_32x32x16_bf16 v[144:159], v[228:231], v[244:247], v[144:159]
    v_mfma_f32_32x32x16_bf16 v[160:175], v[232:235], v[244:247], v[160:175]
    v_mfma_f32_32x32x16_bf16 v[176:191], v[236:239], v[244:247], v[176:191]
    s_waitcnt vmcnt(6) lgkmcnt(0)
    s_barrier
    ds_read_b128 v[240:243], v28 offset:0
    ds_read_b64_tr_b16 v[224:225], v24 offset:0
    ds_read_b64_tr_b16 v[226:227], v24 offset:1024
    v_mfma_f32_32x32x16_bf16 v[128:143], v[192:195], v[248:251], v[128:143]
    ds_read_b64_tr_b16 v[228:229], v25 offset:0
    ds_read_b64_tr_b16 v[230:231], v25 offset:1024
    ds_read_b64_tr_b16 v[232:233], v26 offset:0
    s_add_u32 m0, s52, 49152
    s_mov_b32 s56, 3670016
    buffer_load_dwordx4 v1, s[12:15], s56 offen lds
    v_mfma_f32_32x32x16_bf16 v[144:159], v[196:199], v[248:251], v[144:159]
    ds_read_b64_tr_b16 v[234:235], v26 offset:1024
    ds_read_b64_tr_b16 v[236:237], v27 offset:0
    ds_read_b64_tr_b16 v[238:239], v27 offset:1024
    buffer_load_dwordx4 v13, s[12:15], s56 offen offset:1024 lds
    v_mfma_f32_32x32x16_bf16 v[160:175], v[200:203], v[248:251], v[160:175]
    ds_read_b128 v[244:247], v29 offset:0
    ds_read_b64_tr_b16 v[192:193], v24 offset:4096
    ds_read_b64_tr_b16 v[194:195], v24 offset:5120
    buffer_load_dwordx4 v14, s[12:15], s56 offen offset:2048 lds
    v_mfma_f32_32x32x16_bf16 v[176:191], v[204:207], v[248:251], v[176:191]
    ds_read_b64_tr_b16 v[196:197], v25 offset:4096
    ds_read_b64_tr_b16 v[198:199], v25 offset:5120
    ds_read_b64_tr_b16 v[200:201], v26 offset:4096
    buffer_load_dwordx4 v15, s[12:15], s56 offen offset:3072 lds
    v_mfma_f32_32x32x16_bf16 v[128:143], v[208:211], v[252:255], v[128:143]
    ds_read_b64_tr_b16 v[202:203], v26 offset:5120
    ds_read_b64_tr_b16 v[204:205], v27 offset:4096
    ds_read_b64_tr_b16 v[206:207], v27 offset:5120
    s_add_u32 m0, s53, 49152
    s_mov_b32 s57, 896
    buffer_load_dwordx4 v2, s[8:11], s57 offen nt lds
    v_mfma_f32_32x32x16_bf16 v[144:159], v[212:215], v[252:255], v[144:159]
    ds_read_b128 v[248:251], v30 offset:0
    ds_read_b64_tr_b16 v[208:209], v24 offset:8192
    ds_read_b64_tr_b16 v[210:211], v24 offset:9216
    s_add_u32 m0, s53, 57344
    s_mov_b32 s57, 66432
    buffer_load_dwordx4 v2, s[8:11], s57 offen nt lds
    v_mfma_f32_32x32x16_bf16 v[160:175], v[216:219], v[252:255], v[160:175]
    ds_read_b64_tr_b16 v[212:213], v25 offset:8192
    ds_read_b64_tr_b16 v[214:215], v25 offset:9216
    ds_read_b64_tr_b16 v[216:217], v26 offset:8192
    v_mfma_f32_32x32x16_bf16 v[176:191], v[220:223], v[252:255], v[176:191]
    ds_read_b64_tr_b16 v[218:219], v26 offset:9216
    ds_read_b64_tr_b16 v[220:221], v27 offset:8192
    ds_read_b64_tr_b16 v[222:223], v27 offset:9216
    s_waitcnt lgkmcnt(15)
    v_mfma_f32_32x32x16_bf16 v[128:143], v[224:227], v[240:243], v[128:143]
    ds_read_b128 v[252:255], v31 offset:0
    ds_read_b64_tr_b16 v[224:225], v24 offset:12288
    ds_read_b64_tr_b16 v[226:227], v24 offset:13312
    v_mfma_f32_32x32x16_bf16 v[144:159], v[228:231], v[240:243], v[144:159]
    ds_read_b64_tr_b16 v[228:229], v25 offset:12288
    ds_read_b64_tr_b16 v[230:231], v25 offset:13312
    v_mfma_f32_32x32x16_bf16 v[160:175], v[232:235], v[240:243], v[160:175]
    ds_read_b64_tr_b16 v[232:233], v26 offset:12288
    ds_read_b64_tr_b16 v[234:235], v26 offset:13312
    v_mfma_f32_32x32x16_bf16 v[176:191], v[236:239], v[240:243], v[176:191]
    ds_read_b64_tr_b16 v[236:237], v27 offset:12288
    ds_read_b64_tr_b16 v[238:239], v27 offset:13312
    v_mfma_f32_32x32x16_bf16 v[128:143], v[192:195], v[244:247], v[128:143]
    s_waitcnt lgkmcnt(15)
    v_mfma_f32_32x32x16_bf16 v[144:159], v[196:199], v[244:247], v[144:159]
    v_mfma_f32_32x32x16_bf16 v[160:175], v[200:203], v[244:247], v[160:175]
    v_mfma_f32_32x32x16_bf16 v[176:191], v[204:207], v[244:247], v[176:191]
    s_waitcnt vmcnt(6) lgkmcnt(0)
    s_barrier
    ds_read_b128 v[240:243], v20 offset:0
    ds_read_b64_tr_b16 v[192:193], v16 offset:0
    ds_read_b64_tr_b16 v[194:195], v16 offset:1024
    v_mfma_f32_32x32x16_bf16 v[128:143], v[208:211], v[248:251], v[128:143]
    ds_read_b64_tr_b16 v[196:197], v17 offset:0
    ds_read_b64_tr_b16 v[198:199], v17 offset:1024
    ds_read_b64_tr_b16 v[200:201], v18 offset:0
    s_add_u32 m0, s54, 98304
    s_mov_b32 s58, 0
    buffer_load_dwordx4 v3, s[16:19], 0 offen nt lds
    v_mfma_f32_32x32x16_bf16 v[144:159], v[212:215], v[248:251], v[144:159]
    ds_read_b64_tr_b16 v[202:203], v18 offset:1024
    ds_read_b64_tr_b16 v[204:205], v19 offset:0
    ds_read_b64_tr_b16 v[206:207], v19 offset:1024
    buffer_load_dwordx4 v4, s[16:19], 0 offen offset:1024 nt lds
    v_mfma_f32_32x32x16_bf16 v[160:175], v[216:219], v[248:251], v[160:175]
    ds_read_b128 v[244:247], v21 offset:0
    ds_read_b64_tr_b16 v[208:209], v16 offset:4096
    ds_read_b64_tr_b16 v[210:211], v16 offset:5120
    s_add_u32 m0, s54, 106496
    s_nop 0
    buffer_load_dwordx4 v5, s[20:23], 0 offen nt lds
    v_mfma_f32_32x32x16_bf16 v[176:191], v[220:223], v[248:251], v[176:191]
    ds_read_b64_tr_b16 v[212:213], v17 offset:4096
    ds_read_b64_tr_b16 v[214:215], v17 offset:5120
    ds_read_b64_tr_b16 v[216:217], v18 offset:4096
    buffer_load_dwordx4 v5, s[20:23], 0 offen offset:1024 nt lds
    v_mfma_f32_32x32x16_bf16 v[128:143], v[224:227], v[252:255], v[128:143]
    ds_read_b64_tr_b16 v[218:219], v18 offset:5120
    ds_read_b64_tr_b16 v[220:221], v19 offset:4096
    ds_read_b64_tr_b16 v[222:223], v19 offset:5120
    v_mfma_f32_32x32x16_bf16 v[144:159], v[228:231], v[252:255], v[144:159]
    ds_read_b128 v[248:251], v22 offset:0
    ds_read_b64_tr_b16 v[224:225], v16 offset:8192
    ds_read_b64_tr_b16 v[226:227], v16 offset:9216
    v_mfma_f32_32x32x16_bf16 v[160:175], v[232:235], v[252:255], v[160:175]
    ds_read_b64_tr_b16 v[228:229], v17 offset:8192
    ds_read_b64_tr_b16 v[230:231], v17 offset:9216
    ds_read_b64_tr_b16 v[232:233], v18 offset:8192
    v_mfma_f32_32x32x16_bf16 v[176:191], v[236:239], v[252:255], v[176:191]
    ds_read_b64_tr_b16 v[234:235], v18 offset:9216
    ds_read_b64_tr_b16 v[236:237], v19 offset:8192
    ds_read_b64_tr_b16 v[238:239], v19 offset:9216
    s_waitcnt lgkmcnt(15)
    v_mfma_f32_32x32x16_bf16 v[128:143], v[192:195], v[240:243], v[128:143]
    ds_read_b128 v[252:255], v23 offset:0
    ds_read_b64_tr_b16 v[192:193], v16 offset:12288
    ds_read_b64_tr_b16 v[194:195], v16 offset:13312
    v_mfma_f32_32x32x16_bf16 v[144:159], v[196:199], v[240:243], v[144:159]
    ds_read_b64_tr_b16 v[196:197], v17 offset:12288
    ds_read_b64_tr_b16 v[198:199], v17 offset:13312
    v_mfma_f32_32x32x16_bf16 v[160:175], v[200:203], v[240:243], v[160:175]
    ds_read_b64_tr_b16 v[200:201], v18 offset:12288
    ds_read_b64_tr_b16 v[202:203], v18 offset:13312
    v_mfma_f32_32x32x16_bf16 v[176:191], v[204:207], v[240:243], v[176:191]
    ds_read_b64_tr_b16 v[204:205], v19 offset:12288
    ds_read_b64_tr_b16 v[206:207], v19 offset:13312
    v_mfma_f32_32x32x16_bf16 v[128:143], v[208:211], v[244:247], v[128:143]
    s_waitcnt lgkmcnt(15)
    v_mfma_f32_32x32x16_bf16 v[144:159], v[212:215], v[244:247], v[144:159]
    v_mfma_f32_32x32x16_bf16 v[160:175], v[216:219], v[244:247], v[160:175]
    v_mfma_f32_32x32x16_bf16 v[176:191], v[220:223], v[244:247], v[176:191]
    s_waitcnt vmcnt(4) lgkmcnt(0)
    s_barrier
    ds_read_b128 v[240:243], v20 offset:49152
    ds_read_b64_tr_b16 v[208:209], v16 offset:49152
    ds_read_b64_tr_b16 v[210:211], v16 offset:50176
    v_mfma_f32_32x32x16_bf16 v[128:143], v[224:227], v[248:251], v[128:143]
    ds_read_b64_tr_b16 v[212:213], v17 offset:49152
    ds_read_b64_tr_b16 v[214:215], v17 offset:50176
    ds_read_b64_tr_b16 v[216:217], v18 offset:49152
    s_add_u32 m0, s54, 131072
    s_mov_b32 s58, 8192
    buffer_load_dwordx4 v3, s[16:19], s58 offen nt lds
    v_mfma_f32_32x32x16_bf16 v[144:159], v[228:231], v[248:251], v[144:159]
    ds_read_b64_tr_b16 v[218:219], v18 offset:50176
    ds_read_b64_tr_b16 v[220:221], v19 offset:49152
    ds_read_b64_tr_b16 v[222:223], v19 offset:50176
    buffer_load_dwordx4 v4, s[16:19], s58 offen offset:1024 nt lds
    v_mfma_f32_32x32x16_bf16 v[160:175], v[232:235], v[248:251], v[160:175]
    ds_read_b128 v[244:247], v21 offset:49152
    ds_read_b64_tr_b16 v[224:225], v16 offset:53248
    ds_read_b64_tr_b16 v[226:227], v16 offset:54272
    s_add_u32 m0, s54, 139264
    s_nop 0
    buffer_load_dwordx4 v5, s[20:23], s58 offen nt lds
    v_mfma_f32_32x32x16_bf16 v[176:191], v[236:239], v[248:251], v[176:191]
    ds_read_b64_tr_b16 v[228:229], v17 offset:53248
    ds_read_b64_tr_b16 v[230:231], v17 offset:54272
    ds_read_b64_tr_b16 v[232:233], v18 offset:53248
    buffer_load_dwordx4 v5, s[20:23], s58 offen offset:1024 nt lds
    v_mfma_f32_32x32x16_bf16 v[128:143], v[192:195], v[252:255], v[128:143]
    ds_read_b64_tr_b16 v[234:235], v18 offset:54272
    ds_read_b64_tr_b16 v[236:237], v19 offset:53248
    ds_read_b64_tr_b16 v[238:239], v19 offset:54272
    v_mfma_f32_32x32x16_bf16 v[144:159], v[196:199], v[252:255], v[144:159]
    ds_read_b128 v[248:251], v22 offset:49152
    ds_read_b64_tr_b16 v[192:193], v16 offset:57344
    ds_read_b64_tr_b16 v[194:195], v16 offset:58368
    buffer_atomic_cmpswap_x2 v[80:83], v84, s[48:51], 0 offen
    v_mfma_f32_32x32x16_bf16 v[160:175], v[200:203], v[252:255], v[160:175]
    ds_read_b64_tr_b16 v[196:197], v17 offset:57344
    ds_read_b64_tr_b16 v[198:199], v17 offset:58368
    ds_read_b64_tr_b16 v[200:201], v18 offset:57344
    v_mfma_f32_32x32x16_bf16 v[176:191], v[204:207], v[252:255], v[176:191]
    ds_read_b64_tr_b16 v[202:203], v18 offset:58368
    ds_read_b64_tr_b16 v[204:205], v19 offset:57344
    ds_read_b64_tr_b16 v[206:207], v19 offset:58368
    s_waitcnt lgkmcnt(15)
    v_mfma_f32_32x32x16_bf16 v[128:143], v[208:211], v[240:243], v[128:143]
    ds_read_b128 v[252:255], v23 offset:49152
    ds_read_b64_tr_b16 v[208:209], v16 offset:61440
    ds_read_b64_tr_b16 v[210:211], v16 offset:62464
    v_mfma_f32_32x32x16_bf16 v[144:159], v[212:215], v[240:243], v[144:159]
    ds_read_b64_tr_b16 v[212:213], v17 offset:61440
    ds_read_b64_tr_b16 v[214:215], v17 offset:62464
    v_mfma_f32_32x32x16_bf16 v[160:175], v[216:219], v[240:243], v[160:175]
    ds_read_b64_tr_b16 v[216:217], v18 offset:61440
    ds_read_b64_tr_b16 v[218:219], v18 offset:62464
    v_mfma_f32_32x32x16_bf16 v[176:191], v[220:223], v[240:243], v[176:191]
    ds_read_b64_tr_b16 v[220:221], v19 offset:61440
    ds_read_b64_tr_b16 v[222:223], v19 offset:62464
    v_mfma_f32_32x32x16_bf16 v[128:143], v[224:227], v[244:247], v[128:143]
    s_waitcnt lgkmcnt(15)
    v_mfma_f32_32x32x16_bf16 v[144:159], v[228:231], v[244:247], v[144:159]
    v_mfma_f32_32x32x16_bf16 v[160:175], v[232:235], v[244:247], v[160:175]
    v_mfma_f32_32x32x16_bf16 v[176:191], v[236:239], v[244:247], v[176:191]
    s_waitcnt vmcnt(5) lgkmcnt(0)
    s_barrier
    v_add_u32 v16, 98304, v9
    v_xor_b32 v17, 32, v16
    v_xor_b32 v18, 64, v16
    v_xor_b32 v19, 96, v16
    v_xor_b32 v20, 128, v16
    v_xor_b32 v21, 160, v16
    v_xor_b32 v22, 192, v16
    v_xor_b32 v23, 224, v16
    v_mfma_f32_32x32x16_bf16 v[128:143], v[192:195], v[248:251], v[128:143]
    ds_read_b128 v[192:195], v16
    v_mfma_f32_32x32x16_bf16 v[144:159], v[196:199], v[248:251], v[144:159]
    ds_read_b128 v[196:199], v17
    v_mfma_f32_32x32x16_bf16 v[160:175], v[200:203], v[248:251], v[160:175]
    ds_read_b128 v[200:203], v18
    v_mfma_f32_32x32x16_bf16 v[176:191], v[204:207], v[248:251], v[176:191]
    ds_read_b128 v[204:207], v19
    v_mfma_f32_32x32x16_bf16 v[128:143], v[208:211], v[252:255], v[128:143]
    ds_read_b128 v[208:211], v20
    v_mfma_f32_32x32x16_bf16 v[144:159], v[212:215], v[252:255], v[144:159]
    ds_read_b128 v[212:215], v21
    v_mfma_f32_32x32x16_bf16 v[160:175], v[216:219], v[252:255], v[160:175]
    ds_read_b128 v[216:219], v22
    v_mfma_f32_32x32x16_bf16 v[176:191], v[220:223], v[252:255], v[176:191]
    ds_read_b128 v[220:223], v23
    s_mov_b32 s4, 0x3e0293ee
    s_mov_b32 s5, 0x3e0293ee
    s_nop 6
    v_pk_mul_f32 v[128:129], v[128:129], s[4:5]
    v_pk_mul_f32 v[130:131], v[130:131], s[4:5]
    v_pk_mul_f32 v[132:133], v[132:133], s[4:5]
    v_pk_mul_f32 v[134:135], v[134:135], s[4:5]
    v_cvt_pk_bf16_f32 v96, v128, v129
    v_cvt_pk_bf16_f32 v97, v130, v131
    v_cvt_pk_bf16_f32 v98, v132, v133
    v_cvt_pk_bf16_f32 v99, v134, v135
    v_pk_mul_f32 v[136:137], v[136:137], s[4:5]
    v_pk_mul_f32 v[138:139], v[138:139], s[4:5]
    v_pk_mul_f32 v[140:141], v[140:141], s[4:5]
    v_pk_mul_f32 v[142:143], v[142:143], s[4:5]
    v_cvt_pk_bf16_f32 v100, v136, v137
    v_cvt_pk_bf16_f32 v101, v138, v139
    v_cvt_pk_bf16_f32 v102, v140, v141
    v_cvt_pk_bf16_f32 v103, v142, v143
    v_pk_mul_f32 v[144:145], v[144:145], s[4:5]
    v_pk_mul_f32 v[146:147], v[146:147], s[4:5]
    v_pk_mul_f32 v[148:149], v[148:149], s[4:5]
    v_pk_mul_f32 v[150:151], v[150:151], s[4:5]
    v_cvt_pk_bf16_f32 v104, v144, v145
    v_cvt_pk_bf16_f32 v105, v146, v147
    v_cvt_pk_bf16_f32 v106, v148, v149
    v_cvt_pk_bf16_f32 v107, v150, v151
    v_pk_mul_f32 v[152:153], v[152:153], s[4:5]
    v_pk_mul_f32 v[154:155], v[154:155], s[4:5]
    v_pk_mul_f32 v[156:157], v[156:157], s[4:5]
    v_pk_mul_f32 v[158:159], v[158:159], s[4:5]
    v_cvt_pk_bf16_f32 v108, v152, v153
    v_cvt_pk_bf16_f32 v109, v154, v155
    v_cvt_pk_bf16_f32 v110, v156, v157
    v_cvt_pk_bf16_f32 v111, v158, v159
    v_pk_mul_f32 v[160:161], v[160:161], s[4:5]
    v_pk_mul_f32 v[162:163], v[162:163], s[4:5]
    v_pk_mul_f32 v[164:165], v[164:165], s[4:5]
    v_pk_mul_f32 v[166:167], v[166:167], s[4:5]
    v_cvt_pk_bf16_f32 v112, v160, v161
    v_cvt_pk_bf16_f32 v113, v162, v163
    v_cvt_pk_bf16_f32 v114, v164, v165
    v_cvt_pk_bf16_f32 v115, v166, v167
    v_pk_mul_f32 v[168:169], v[168:169], s[4:5]
    v_pk_mul_f32 v[170:171], v[170:171], s[4:5]
    v_pk_mul_f32 v[172:173], v[172:173], s[4:5]
    v_pk_mul_f32 v[174:175], v[174:175], s[4:5]
    v_cvt_pk_bf16_f32 v116, v168, v169
    v_cvt_pk_bf16_f32 v117, v170, v171
    v_cvt_pk_bf16_f32 v118, v172, v173
    v_cvt_pk_bf16_f32 v119, v174, v175
    v_pk_mul_f32 v[176:177], v[176:177], s[4:5]
    v_pk_mul_f32 v[178:179], v[178:179], s[4:5]
    v_pk_mul_f32 v[180:181], v[180:181], s[4:5]
    v_pk_mul_f32 v[182:183], v[182:183], s[4:5]
    v_cvt_pk_bf16_f32 v120, v176, v177
    v_cvt_pk_bf16_f32 v121, v178, v179
    v_cvt_pk_bf16_f32 v122, v180, v181
    v_cvt_pk_bf16_f32 v123, v182, v183
    v_pk_mul_f32 v[184:185], v[184:185], s[4:5]
    v_pk_mul_f32 v[186:187], v[186:187], s[4:5]
    v_pk_mul_f32 v[188:189], v[188:189], s[4:5]
    v_pk_mul_f32 v[190:191], v[190:191], s[4:5]
    v_cvt_pk_bf16_f32 v124, v184, v185
    v_cvt_pk_bf16_f32 v125, v186, v187
    v_cvt_pk_bf16_f32 v126, v188, v189
    v_cvt_pk_bf16_f32 v127, v190, v191
    v_add_u32 v28, 7168, v6
    v_add_u32 v29, 14336, v6
    v_add_u32 v30, 21504, v6
    s_mov_b32 s43, 0x43800000
    s_cmp_eq_u32 s41, 0
    s_cbranch_scc1 ASTART
    s_barrier
ASTART:
    v_add_u32 v24, 98304, v10
    v_xor_b32 v25, 64, v24
    v_xor_b32 v26, 128, v24
    v_xor_b32 v27, 192, v24
    s_waitcnt lgkmcnt(7)
    v_mfma_f32_32x32x16_bf16 v[128:143], v[192:195], v[96:99], 0
    s_add_u32 m0, s54, 0
    s_mov_b32 s58, 16384
    buffer_load_dwordx4 v3, s[16:19], s58 offen nt lds
    ds_read_b64_tr_b16 v[160:161], v24 offset:0
    ds_read_b64_tr_b16 v[162:163], v24 offset:2048
    s_waitcnt lgkmcnt(8)
    v_mfma_f32_32x32x16_bf16 v[128:143], v[196:199], v[100:103], v[128:143]
    buffer_load_dwordx4 v4, s[16:19], s58 offen offset:1024 nt lds
    ds_read_b64_tr_b16 v[164:165], v25 offset:0
    ds_read_b64_tr_b16 v[166:167], v25 offset:2048
    s_waitcnt lgkmcnt(9)
    v_mfma_f32_32x32x16_bf16 v[128:143], v[200:203], v[104:107], v[128:143]
    s_add_u32 m0, s54, 8192
    s_nop 0
    buffer_load_dwordx4 v5, s[20:23], s58 offen nt lds
    ds_read_b64_tr_b16 v[168:169], v26 offset:0
    ds_read_b64_tr_b16 v[170:171], v26 offset:2048
    s_waitcnt lgkmcnt(10)
    v_mfma_f32_32x32x16_bf16 v[128:143], v[204:207], v[108:111], v[128:143]
    buffer_load_dwordx4 v5, s[20:23], s58 offen offset:1024 nt lds
    ds_read_b64_tr_b16 v[172:173], v27 offset:0
    ds_read_b64_tr_b16 v[174:175], v27 offset:2048
    s_waitcnt lgkmcnt(11)
    v_mfma_f32_32x32x16_bf16 v[128:143], v[208:211], v[112:115], v[128:143]
    ds_read_b64_tr_b16 v[176:177], v24 offset:4096
    ds_read_b64_tr_b16 v[178:179], v24 offset:6144
    s_waitcnt lgkmcnt(12)
    v_mfma_f32_32x32x16_bf16 v[128:143], v[212:215], v[116:119], v[128:143]
    ds_read_b64_tr_b16 v[180:181], v25 offset:4096
    ds_read_b64_tr_b16 v[182:183], v25 offset:6144
    s_waitcnt lgkmcnt(13)
    v_mfma_f32_32x32x16_bf16 v[128:143], v[216:219], v[120:123], v[128:143]
    ds_read_b64_tr_b16 v[184:185], v26 offset:4096
    ds_read_b64_tr_b16 v[186:187], v26 offset:6144
    s_waitcnt lgkmcnt(14)
    v_mfma_f32_32x32x16_bf16 v[128:143], v[220:223], v[124:127], v[128:143]
    ds_read_b64_tr_b16 v[188:189], v27 offset:4096
    ds_read_b64_tr_b16 v[190:191], v27 offset:6144
    s_waitcnt vmcnt(5)
    s_barrier
    v_add_u32 v16, 131072, v9
    v_xor_b32 v17, 32, v16
    v_xor_b32 v18, 64, v16
    v_xor_b32 v19, 96, v16
    v_xor_b32 v20, 128, v16
    v_xor_b32 v21, 160, v16
    v_xor_b32 v22, 192, v16
    v_xor_b32 v23, 224, v16
    s_nop 2
    v_max3_f32 v14, v128, v129, v130
    v_max3_f32 v15, v131, v132, v133
    v_max3_f32 v14, v14, v134, v135
    v_max3_f32 v15, v15, v136, v137
    v_max3_f32 v14, v14, v138, v139
    v_max3_f32 v15, v15, v140, v141
    v_max3_f32 v14, v14, v142, v143
    v_max_f32 v14, v14, v15
    v_mov_b32 v15, v14
    s_nop 1
    v_permlane32_swap_b32 v14, v15
    s_nop 1
    v_max_f32 v14, v14, v15
    v_sub_f32 v144, 0, v14
    v_sub_f32 v128, v128, v14
    v_sub_f32 v129, v129, v14
    v_sub_f32 v130, v130, v14
    v_sub_f32 v131, v131, v14
    v_sub_f32 v132, v132, v14
    v_sub_f32 v133, v133, v14
    v_sub_f32 v134, v134, v14
    v_sub_f32 v135, v135, v14
    v_sub_f32 v136, v136, v14
    v_sub_f32 v137, v137, v14
    v_sub_f32 v138, v138, v14
    v_sub_f32 v139, v139, v14
    v_sub_f32 v140, v140, v14
    v_sub_f32 v141, v141, v14
    v_sub_f32 v142, v142, v14
    v_sub_f32 v143, v143, v14
    v_mov_b32 v145, v144
    v_mov_b32 v146, v144
    v_mov_b32 v147, v144
    v_mov_b32 v148, v144
    v_mov_b32 v149, v144
    v_mov_b32 v150, v144
    v_mov_b32 v151, v144
    v_mov_b32 v152, v144
    v_mov_b32 v153, v144
    v_mov_b32 v154, v144
    v_mov_b32 v155, v144
    v_mov_b32 v156, v144
    v_mov_b32 v157, v144
    v_mov_b32 v158, v144
    v_mov_b32 v159, v144
    v_exp_f32 v128, v128
    v_exp_f32 v129, v129
    v_exp_f32 v130, v130
    v_exp_f32 v131, v131
    v_add_f32 v15, v128, v129
    v_exp_f32 v132, v132
    v_add_f32 v31, v130, v131
    v_exp_f32 v133, v133
    v_add_f32 v15, v15, v132
    v_exp_f32 v134, v134
    v_add_f32 v31, v31, v133
    v_exp_f32 v135, v135
    v_add_f32 v15, v15, v134
    v_exp_f32 v136, v136
    v_add_f32 v31, v31, v135
    v_exp_f32 v137, v137
    v_add_f32 v15, v15, v136
    v_exp_f32 v138, v138
    v_add_f32 v31, v31, v137
    v_exp_f32 v139, v139
    v_add_f32 v15, v15, v138
    v_exp_f32 v140, v140
    v_add_f32 v31, v31, v139
    v_exp_f32 v141, v141
    v_add_f32 v15, v15, v140
    v_exp_f32 v142, v142
    v_add_f32 v31, v31, v141
    v_exp_f32 v143, v143
    v_add_f32 v15, v15, v142
    v_add_f32 v15, v15, v31
    v_add_f32 v15, v15, v143
    v_mov_b32 v13, v15
    ds_read_b128 v[192:195], v16
    ds_read_b128 v[196:199], v17
    ds_read_b128 v[200:203], v18
    ds_read_b128 v[204:207], v19
    ds_read_b128 v[208:211], v20
    ds_read_b128 v[212:215], v21
    ds_read_b128 v[216:219], v22
    ds_read_b128 v[220:223], v23
    v_cvt_pk_bf16_f32 v128, v128, v129
    v_cvt_pk_bf16_f32 v129, v130, v131
    v_cvt_pk_bf16_f32 v130, v132, v133
    v_cvt_pk_bf16_f32 v131, v134, v135
    v_cvt_pk_bf16_f32 v132, v136, v137
    v_cvt_pk_bf16_f32 v133, v138, v139
    v_cvt_pk_bf16_f32 v134, v140, v141
    v_cvt_pk_bf16_f32 v135, v142, v143
    s_waitcnt lgkmcnt(8)
    s_barrier
    v_mfma_f32_32x32x16_bf16 v[32:47], v[160:163], v[128:131], 0
    s_add_u32 m0, s54, 32768
    s_mov_b32 s58, 24576
    buffer_load_dwordx4 v3, s[16:19], s58 offen nt lds
    v_mfma_f32_32x32x16_bf16 v[48:63], v[164:167], v[128:131], 0
    buffer_load_dwordx4 v4, s[16:19], s58 offen offset:1024 nt lds
    v_mfma_f32_32x32x16_bf16 v[64:79], v[168:171], v[128:131], 0
    s_add_u32 m0, s54, 40960
    s_nop 0
    buffer_load_dwordx4 v5, s[20:23], s58 offen nt lds
    v_mfma_f32_32x32x16_bf16 v[80:95], v[172:175], v[128:131], 0
    buffer_load_dwordx4 v5, s[20:23], s58 offen offset:1024 nt lds
    v_mfma_f32_32x32x16_bf16 v[32:47], v[176:179], v[132:135], v[32:47]
    v_add_u32 v24, 131072, v10
    v_xor_b32 v25, 64, v24
    v_xor_b32 v26, 128, v24
    v_xor_b32 v27, 192, v24
    v_mfma_f32_32x32x16_bf16 v[48:63], v[180:183], v[132:135], v[48:63]
    ds_read_b64_tr_b16 v[160:161], v24 offset:0
    ds_read_b64_tr_b16 v[162:163], v24 offset:2048
    v_mfma_f32_32x32x16_bf16 v[64:79], v[184:187], v[132:135], v[64:79]
    ds_read_b64_tr_b16 v[164:165], v25 offset:0
    ds_read_b64_tr_b16 v[166:167], v25 offset:2048
    v_mfma_f32_32x32x16_bf16 v[80:95], v[188:191], v[132:135], v[80:95]
    ds_read_b64_tr_b16 v[168:169], v26 offset:0
    ds_read_b64_tr_b16 v[170:171], v26 offset:2048
    s_waitcnt lgkmcnt(13)
    v_mfma_f32_32x32x16_bf16 v[128:143], v[192:195], v[96:99], v[144:159]
    ds_read_b64_tr_b16 v[172:173], v27 offset:0
    ds_read_b64_tr_b16 v[174:175], v27 offset:2048
    s_waitcnt lgkmcnt(14)
    v_mfma_f32_32x32x16_bf16 v[128:143], v[196:199], v[100:103], v[128:143]
    ds_read_b64_tr_b16 v[176:177], v24 offset:4096
    ds_read_b64_tr_b16 v[178:179], v24 offset:6144
    s_waitcnt lgkmcnt(15)
    v_mfma_f32_32x32x16_bf16 v[128:143], v[200:203], v[104:107], v[128:143]
    ds_read_b64_tr_b16 v[180:181], v25 offset:4096
    ds_read_b64_tr_b16 v[182:183], v25 offset:6144
    s_waitcnt lgkmcnt(15)
    v_mfma_f32_32x32x16_bf16 v[128:143], v[204:207], v[108:111], v[128:143]
    ds_read_b64_tr_b16 v[184:185], v26 offset:4096
    ds_read_b64_tr_b16 v[186:187], v26 offset:6144
    v_mfma_f32_32x32x16_bf16 v[128:143], v[208:211], v[112:115], v[128:143]
    ds_read_b64_tr_b16 v[188:189], v27 offset:4096
    ds_read_b64_tr_b16 v[190:191], v27 offset:6144
    s_waitcnt lgkmcnt(15)
    v_mfma_f32_32x32x16_bf16 v[128:143], v[212:215], v[116:119], v[128:143]
    v_mfma_f32_32x32x16_bf16 v[128:143], v[216:219], v[120:123], v[128:143]
    v_mfma_f32_32x32x16_bf16 v[128:143], v[220:223], v[124:127], v[128:143]
    s_waitcnt vmcnt(4)
    s_barrier
    v_add_u32 v16, 0, v9
    v_xor_b32 v17, 32, v16
    v_xor_b32 v18, 64, v16
    v_xor_b32 v19, 96, v16
    v_xor_b32 v20, 128, v16
    v_xor_b32 v21, 160, v16
    v_xor_b32 v22, 192, v16
    v_xor_b32 v23, 224, v16
    s_nop 2
    v_exp_f32 v128, v128
    v_exp_f32 v129, v129
    v_exp_f32 v130, v130
    v_exp_f32 v131, v131
    v_add_f32 v15, v128, v129
    v_exp_f32 v132, v132
    v_add_f32 v31, v130, v131
    v_exp_f32 v133, v133
    v_add_f32 v15, v15, v132
    v_exp_f32 v134, v134
    v_add_f32 v31, v31, v133
    v_exp_f32 v135, v135
    v_add_f32 v15, v15, v134
    v_exp_f32 v136, v136
    v_add_f32 v31, v31, v135
    v_exp_f32 v137, v137
    v_add_f32 v15, v15, v136
    v_exp_f32 v138, v138
    v_add_f32 v31, v31, v137
    v_exp_f32 v139, v139
    v_add_f32 v15, v15, v138
    v_exp_f32 v140, v140
    v_add_f32 v31, v31, v139
    v_exp_f32 v141, v141
    v_add_f32 v15, v15, v140
    v_exp_f32 v142, v142
    v_add_f32 v31, v31, v141
    v_exp_f32 v143, v143
    v_add_f32 v15, v15, v142
    v_add_f32 v15, v15, v31
    v_add_f32 v15, v15, v143
    v_cmp_lt_f32 vcc, s43, v15
    s_cbranch_vccnz SLOWS1
SLOWR1:
    ds_read_b128 v[192:195], v16
    ds_read_b128 v[196:199], v17
    ds_read_b128 v[200:203], v18
    ds_read_b128 v[204:207], v19
    ds_read_b128 v[208:211], v20
    ds_read_b128 v[212:215], v21
    ds_read_b128 v[216:219], v22
    ds_read_b128 v[220:223], v23
    v_add_f32 v13, v13, v15
    v_cvt_pk_bf16_f32 v128, v128, v129
    v_cvt_pk_bf16_f32 v129, v130, v131
    v_cvt_pk_bf16_f32 v130, v132, v133
    v_cvt_pk_bf16_f32 v131, v134, v135
    v_cvt_pk_bf16_f32 v132, v136, v137
    v_cvt_pk_bf16_f32 v133, v138, v139
    v_cvt_pk_bf16_f32 v134, v140, v141
    v_cvt_pk_bf16_f32 v135, v142, v143
    s_waitcnt lgkmcnt(8)
    s_barrier
    v_mfma_f32_32x32x16_bf16 v[32:47], v[160:163], v[128:131], v[32:47]
    s_add_u32 m0, s54, 65536
    s_mov_b32 s58, 32768
    buffer_load_dwordx4 v3, s[16:19], s58 offen nt lds
    v_mfma_f32_32x32x16_bf16 v[48:63], v[164:167], v[128:131], v[48:63]
    buffer_load_dwordx4 v4, s[16:19], s58 offen offset:1024 nt lds
    v_mfma_f32_32x32x16_bf16 v[64:79], v[168:171], v[128:131], v[64:79]
    s_add_u32 m0, s54, 73728
    s_nop 0
    buffer_load_dwordx4 v5, s[20:23], s58 offen nt lds
    v_mfma_f32_32x32x16_bf16 v[80:95], v[172:175], v[128:131], v[80:95]
    buffer_load_dwordx4 v5, s[20:23], s58 offen offset:1024 nt lds
    v_mfma_f32_32x32x16_bf16 v[32:47], v[176:179], v[132:135], v[32:47]
    v_add_u32 v24, 0, v10
    v_xor_b32 v25, 64, v24
    v_xor_b32 v26, 128, v24
    v_xor_b32 v27, 192, v24
    v_mfma_f32_32x32x16_bf16 v[48:63], v[180:183], v[132:135], v[48:63]
    ds_read_b64_tr_b16 v[160:161], v24 offset:0
    ds_read_b64_tr_b16 v[162:163], v24 offset:2048
    v_mfma_f32_32x32x16_bf16 v[64:79], v[184:187], v[132:135], v[64:79]
    ds_read_b64_tr_b16 v[164:165], v25 offset:0
    ds_read_b64_tr_b16 v[166:167], v25 offset:2048
    v_mfma_f32_32x32x16_bf16 v[80:95], v[188:191], v[132:135], v[80:95]
    ds_read_b64_tr_b16 v[168:169], v26 offset:0
    ds_read_b64_tr_b16 v[170:171], v26 offset:2048
    s_waitcnt lgkmcnt(13)
    v_mfma_f32_32x32x16_bf16 v[128:143], v[192:195], v[96:99], v[144:159]
    ds_read_b64_tr_b16 v[172:173], v27 offset:0
    ds_read_b64_tr_b16 v[174:175], v27 offset:2048
    s_waitcnt lgkmcnt(14)
    v_mfma_f32_32x32x16_bf16 v[128:143], v[196:199], v[100:103], v[128:143]
    ds_read_b64_tr_b16 v[176:177], v24 offset:4096
    ds_read_b64_tr_b16 v[178:179], v24 offset:6144
    s_waitcnt lgkmcnt(15)
    v_mfma_f32_32x32x16_bf16 v[128:143], v[200:203], v[104:107], v[128:143]
    ds_read_b64_tr_b16 v[180:181], v25 offset:4096
    ds_read_b64_tr_b16 v[182:183], v25 offset:6144
    s_waitcnt lgkmcnt(15)
    v_mfma_f32_32x32x16_bf16 v[128:143], v[204:207], v[108:111], v[128:143]
    ds_read_b64_tr_b16 v[184:185], v26 offset:4096
    ds_read_b64_tr_b16 v[186:187], v26 offset:6144
    v_mfma_f32_32x32x16_bf16 v[128:143], v[208:211], v[112:115], v[128:143]
    ds_read_b64_tr_b16 v[188:189], v27 offset:4096
    ds_read_b64_tr_b16 v[190:191], v27 offset:6144
    s_waitcnt lgkmcnt(15)
    v_mfma_f32_32x32x16_bf16 v[128:143], v[212:215], v[116:119], v[128:143]
    v_mfma_f32_32x32x16_bf16 v[128:143], v[216:219], v[120:123], v[128:143]
    v_mfma_f32_32x32x16_bf16 v[128:143], v[220:223], v[124:127], v[128:143]
    s_waitcnt vmcnt(4)
    s_barrier
    v_add_u32 v16, 32768, v9
    v_xor_b32 v17, 32, v16
    v_xor_b32 v18, 64, v16
    v_xor_b32 v19, 96, v16
    v_xor_b32 v20, 128, v16
    v_xor_b32 v21, 160, v16
    v_xor_b32 v22, 192, v16
    v_xor_b32 v23, 224, v16
    s_nop 2
    v_exp_f32 v128, v128
    v_exp_f32 v129, v129
    v_exp_f32 v130, v130
    v_exp_f32 v131, v131
    v_add_f32 v15, v128, v129
    v_exp_f32 v132, v132
    v_add_f32 v31, v130, v131
    v_exp_f32 v133, v133
    v_add_f32 v15, v15, v132
    v_exp_f32 v134, v134
    v_add_f32 v31, v31, v133
    v_exp_f32 v135, v135
    v_add_f32 v15, v15, v134
    v_exp_f32 v136, v136
    v_add_f32 v31, v31, v135
    v_exp_f32 v137, v137
    v_add_f32 v15, v15, v136
    v_exp_f32 v138, v138
    v_add_f32 v31, v31, v137
    v_exp_f32 v139, v139
    v_add_f32 v15, v15, v138
    v_exp_f32 v140, v140
    v_add_f32 v31, v31, v139
    v_exp_f32 v141, v141
    v_add_f32 v15, v15, v140
    v_exp_f32 v142, v142
    v_add_f32 v31, v31, v141
    v_exp_f32 v143, v143
    v_add_f32 v15, v15, v142
    v_add_f32 v15, v15, v31
    v_add_f32 v15, v15, v143
    v_cmp_lt_f32 vcc, s43, v15
    s_cbranch_vccnz SLOWS2
SLOWR2:
    ds_read_b128 v[192:195], v16
    ds_read_b128 v[196:199], v17
    ds_read_b128 v[200:203], v18
    ds_read_b128 v[204:207], v19
    ds_read_b128 v[208:211], v20
    ds_read_b128 v[212:215], v21
    ds_read_b128 v[216:219], v22
    ds_read_b128 v[220:223], v23
    v_add_f32 v13, v13, v15
    v_cvt_pk_bf16_f32 v128, v128, v129
    v_cvt_pk_bf16_f32 v129, v130, v131
    v_cvt_pk_bf16_f32 v130, v132, v133
    v_cvt_pk_bf16_f32 v131, v134, v135
    v_cvt_pk_bf16_f32 v132, v136, v137
    v_cvt_pk_bf16_f32 v133, v138, v139
    v_cvt_pk_bf16_f32 v134, v140, v141
    v_cvt_pk_bf16_f32 v135, v142, v143
    s_waitcnt lgkmcnt(8)
    s_barrier
    v_mfma_f32_32x32x16_bf16 v[32:47], v[160:163], v[128:131], v[32:47]
    s_add_u32 m0, s54, 98304
    s_mov_b32 s58, 40960
    buffer_load_dwordx4 v3, s[16:19], s58 offen nt lds
    v_mfma_f32_32x32x16_bf16 v[48:63], v[164:167], v[128:131], v[48:63]
    buffer_load_dwordx4 v4, s[16:19], s58 offen offset:1024 nt lds
    v_mfma_f32_32x32x16_bf16 v[64:79], v[168:171], v[128:131], v[64:79]
    s_add_u32 m0, s54, 106496
    s_nop 0
    buffer_load_dwordx4 v5, s[20:23], s58 offen nt lds
    v_mfma_f32_32x32x16_bf16 v[80:95], v[172:175], v[128:131], v[80:95]
    buffer_load_dwordx4 v5, s[20:23], s58 offen offset:1024 nt lds
    v_mfma_f32_32x32x16_bf16 v[32:47], v[176:179], v[132:135], v[32:47]
    v_add_u32 v24, 32768, v10
    v_xor_b32 v25, 64, v24
    v_xor_b32 v26, 128, v24
    v_xor_b32 v27, 192, v24
    v_mfma_f32_32x32x16_bf16 v[48:63], v[180:183], v[132:135], v[48:63]
    ds_read_b64_tr_b16 v[160:161], v24 offset:0
    ds_read_b64_tr_b16 v[162:163], v24 offset:2048
    v_mfma_f32_32x32x16_bf16 v[64:79], v[184:187], v[132:135], v[64:79]
    ds_read_b64_tr_b16 v[164:165], v25 offset:0
    ds_read_b64_tr_b16 v[166:167], v25 offset:2048
    v_mfma_f32_32x32x16_bf16 v[80:95], v[188:191], v[132:135], v[80:95]
    ds_read_b64_tr_b16 v[168:169], v26 offset:0
    ds_read_b64_tr_b16 v[170:171], v26 offset:2048
    s_waitcnt lgkmcnt(13)
    v_mfma_f32_32x32x16_bf16 v[128:143], v[192:195], v[96:99], v[144:159]
    ds_read_b64_tr_b16 v[172:173], v27 offset:0
    ds_read_b64_tr_b16 v[174:175], v27 offset:2048
    s_waitcnt lgkmcnt(14)
    v_mfma_f32_32x32x16_bf16 v[128:143], v[196:199], v[100:103], v[128:143]
    ds_read_b64_tr_b16 v[176:177], v24 offset:4096
    ds_read_b64_tr_b16 v[178:179], v24 offset:6144
    s_waitcnt lgkmcnt(15)
    v_mfma_f32_32x32x16_bf16 v[128:143], v[200:203], v[104:107], v[128:143]
    ds_read_b64_tr_b16 v[180:181], v25 offset:4096
    ds_read_b64_tr_b16 v[182:183], v25 offset:6144
    s_waitcnt lgkmcnt(15)
    v_mfma_f32_32x32x16_bf16 v[128:143], v[204:207], v[108:111], v[128:143]
    ds_read_b64_tr_b16 v[184:185], v26 offset:4096
    ds_read_b64_tr_b16 v[186:187], v26 offset:6144
    v_mfma_f32_32x32x16_bf16 v[128:143], v[208:211], v[112:115], v[128:143]
    ds_read_b64_tr_b16 v[188:189], v27 offset:4096
    ds_read_b64_tr_b16 v[190:191], v27 offset:6144
    s_waitcnt lgkmcnt(15)
    v_mfma_f32_32x32x16_bf16 v[128:143], v[212:215], v[116:119], v[128:143]
    v_mfma_f32_32x32x16_bf16 v[128:143], v[216:219], v[120:123], v[128:143]
    v_mfma_f32_32x32x16_bf16 v[128:143], v[220:223], v[124:127], v[128:143]
    s_waitcnt vmcnt(4)
    s_barrier
    v_add_u32 v16, 65536, v9
    v_xor_b32 v17, 32, v16
    v_xor_b32 v18, 64, v16
    v_xor_b32 v19, 96, v16
    v_xor_b32 v20, 128, v16
    v_xor_b32 v21, 160, v16
    v_xor_b32 v22, 192, v16
    v_xor_b32 v23, 224, v16
    s_nop 2
    v_exp_f32 v128, v128
    v_exp_f32 v129, v129
    v_exp_f32 v130, v130
    v_exp_f32 v131, v131
    v_add_f32 v15, v128, v129
    v_exp_f32 v132, v132
    v_add_f32 v31, v130, v131
    v_exp_f32 v133, v133
    v_add_f32 v15, v15, v132
    v_exp_f32 v134, v134
    v_add_f32 v31, v31, v133
    v_exp_f32 v135, v135
    v_add_f32 v15, v15, v134
    v_exp_f32 v136, v136
    v_add_f32 v31, v31, v135
    v_exp_f32 v137, v137
    v_add_f32 v15, v15, v136
    v_exp_f32 v138, v138
    v_add_f32 v31, v31, v137
    v_exp_f32 v139, v139
    v_add_f32 v15, v15, v138
    v_exp_f32 v140, v140
    v_add_f32 v31, v31, v139
    v_exp_f32 v141, v141
    v_add_f32 v15, v15, v140
    v_exp_f32 v142, v142
    v_add_f32 v31, v31, v141
    v_exp_f32 v143, v143
    v_add_f32 v15, v15, v142
    v_add_f32 v15, v15, v31
    v_add_f32 v15, v15, v143
    v_cmp_lt_f32 vcc, s43, v15
    s_cbranch_vccnz SLOWS3
SLOWR3:
    ds_read_b128 v[192:195], v16
    ds_read_b128 v[196:199], v17
    ds_read_b128 v[200:203], v18
    ds_read_b128 v[204:207], v19
    ds_read_b128 v[208:211], v20
    ds_read_b128 v[212:215], v21
    ds_read_b128 v[216:219], v22
    ds_read_b128 v[220:223], v23
    v_add_f32 v13, v13, v15
    v_cvt_pk_bf16_f32 v128, v128, v129
    v_cvt_pk_bf16_f32 v129, v130, v131
    v_cvt_pk_bf16_f32 v130, v132, v133
    v_cvt_pk_bf16_f32 v131, v134, v135
    v_cvt_pk_bf16_f32 v132, v136, v137
    v_cvt_pk_bf16_f32 v133, v138, v139
    v_cvt_pk_bf16_f32 v134, v140, v141
    v_cvt_pk_bf16_f32 v135, v142, v143
    s_waitcnt lgkmcnt(8)
    s_barrier
    v_mfma_f32_32x32x16_bf16 v[32:47], v[160:163], v[128:131], v[32:47]
    s_add_u32 m0, s54, 131072
    s_mov_b32 s58, 49152
    buffer_load_dwordx4 v3, s[16:19], s58 offen nt lds
    v_mfma_f32_32x32x16_bf16 v[48:63], v[164:167], v[128:131], v[48:63]
    buffer_load_dwordx4 v4, s[16:19], s58 offen offset:1024 nt lds
    v_mfma_f32_32x32x16_bf16 v[64:79], v[168:171], v[128:131], v[64:79]
    s_add_u32 m0, s54, 139264
    s_nop 0
    buffer_load_dwordx4 v5, s[20:23], s58 offen nt lds
    v_mfma_f32_32x32x16_bf16 v[80:95], v[172:175], v[128:131], v[80:95]
    buffer_load_dwordx4 v5, s[20:23], s58 offen offset:1024 nt lds
    v_mfma_f32_32x32x16_bf16 v[32:47], v[176:179], v[132:135], v[32:47]
    v_add_u32 v24, 65536, v10
    v_xor_b32 v25, 64, v24
    v_xor_b32 v26, 128, v24
    v_xor_b32 v27, 192, v24
    v_mfma_f32_32x32x16_bf16 v[48:63], v[180:183], v[132:135], v[48:63]
    ds_read_b64_tr_b16 v[160:161], v24 offset:0
    ds_read_b64_tr_b16 v[162:163], v24 offset:2048
    v_mfma_f32_32x32x16_bf16 v[64:79], v[184:187], v[132:135], v[64:79]
    ds_read_b64_tr_b16 v[164:165], v25 offset:0
    ds_read_b64_tr_b16 v[166:167], v25 offset:2048
    v_mfma_f32_32x32x16_bf16 v[80:95], v[188:191], v[132:135], v[80:95]
    ds_read_b64_tr_b16 v[168:169], v26 offset:0
    ds_read_b64_tr_b16 v[170:171], v26 offset:2048
    s_waitcnt lgkmcnt(13)
    v_mfma_f32_32x32x16_bf16 v[128:143], v[192:195], v[96:99], v[144:159]
    ds_read_b64_tr_b16 v[172:173], v27 offset:0
    ds_read_b64_tr_b16 v[174:175], v27 offset:2048
    s_waitcnt lgkmcnt(14)
    v_mfma_f32_32x32x16_bf16 v[128:143], v[196:199], v[100:103], v[128:143]
    ds_read_b64_tr_b16 v[176:177], v24 offset:4096
    ds_read_b64_tr_b16 v[178:179], v24 offset:6144
    s_waitcnt lgkmcnt(15)
    v_mfma_f32_32x32x16_bf16 v[128:143], v[200:203], v[104:107], v[128:143]
    ds_read_b64_tr_b16 v[180:181], v25 offset:4096
    ds_read_b64_tr_b16 v[182:183], v25 offset:6144
    s_waitcnt lgkmcnt(15)
    v_mfma_f32_32x32x16_bf16 v[128:143], v[204:207], v[108:111], v[128:143]
    ds_read_b64_tr_b16 v[184:185], v26 offset:4096
    ds_read_b64_tr_b16 v[186:187], v26 offset:6144
    v_mfma_f32_32x32x16_bf16 v[128:143], v[208:211], v[112:115], v[128:143]
    ds_read_b64_tr_b16 v[188:189], v27 offset:4096
    ds_read_b64_tr_b16 v[190:191], v27 offset:6144
    s_waitcnt lgkmcnt(15)
    v_mfma_f32_32x32x16_bf16 v[128:143], v[212:215], v[116:119], v[128:143]
    v_mfma_f32_32x32x16_bf16 v[128:143], v[216:219], v[120:123], v[128:143]
    v_mfma_f32_32x32x16_bf16 v[128:143], v[220:223], v[124:127], v[128:143]
    s_waitcnt vmcnt(4)
    s_barrier
    v_add_u32 v16, 98304, v9
    v_xor_b32 v17, 32, v16
    v_xor_b32 v18, 64, v16
    v_xor_b32 v19, 96, v16
    v_xor_b32 v20, 128, v16
    v_xor_b32 v21, 160, v16
    v_xor_b32 v22, 192, v16
    v_xor_b32 v23, 224, v16
    s_nop 2
    v_exp_f32 v128, v128
    v_exp_f32 v129, v129
    v_exp_f32 v130, v130
    v_exp_f32 v131, v131
    v_add_f32 v15, v128, v129
    v_exp_f32 v132, v132
    v_add_f32 v31, v130, v131
    v_exp_f32 v133, v133
    v_add_f32 v15, v15, v132
    v_exp_f32 v134, v134
    v_add_f32 v31, v31, v133
    v_exp_f32 v135, v135
    v_add_f32 v15, v15, v134
    v_exp_f32 v136, v136
    v_add_f32 v31, v31, v135
    v_exp_f32 v137, v137
    v_add_f32 v15, v15, v136
    v_exp_f32 v138, v138
    v_add_f32 v31, v31, v137
    v_exp_f32 v139, v139
    v_add_f32 v15, v15, v138
    v_exp_f32 v140, v140
    v_add_f32 v31, v31, v139
    v_exp_f32 v141, v141
    v_add_f32 v15, v15, v140
    v_exp_f32 v142, v142
    v_add_f32 v31, v31, v141
    v_exp_f32 v143, v143
    v_add_f32 v15, v15, v142
    v_add_f32 v15, v15, v31
    v_add_f32 v15, v15, v143
    v_cmp_lt_f32 vcc, s43, v15
    s_cbranch_vccnz SLOWS4
SLOWR4:
    ds_read_b128 v[192:195], v16
    ds_read_b128 v[196:199], v17
    ds_read_b128 v[200:203], v18
    ds_read_b128 v[204:207], v19
    ds_read_b128 v[208:211], v20
    ds_read_b128 v[212:215], v21
    ds_read_b128 v[216:219], v22
    ds_read_b128 v[220:223], v23
    v_add_f32 v13, v13, v15
    v_cvt_pk_bf16_f32 v128, v128, v129
    v_cvt_pk_bf16_f32 v129, v130, v131
    v_cvt_pk_bf16_f32 v130, v132, v133
    v_cvt_pk_bf16_f32 v131, v134, v135
    v_cvt_pk_bf16_f32 v132, v136, v137
    v_cvt_pk_bf16_f32 v133, v138, v139
    v_cvt_pk_bf16_f32 v134, v140, v141
    v_cvt_pk_bf16_f32 v135, v142, v143
    s_waitcnt lgkmcnt(8)
    s_barrier
    v_mfma_f32_32x32x16_bf16 v[32:47], v[160:163], v[128:131], v[32:47]
    s_add_u32 m0, s54, 0
    s_mov_b32 s58, 57344
    buffer_load_dwordx4 v3, s[16:19], s58 offen nt lds
    v_mfma_f32_32x32x16_bf16 v[48:63], v[164:167], v[128:131], v[48:63]
    buffer_load_dwordx4 v4, s[16:19], s58 offen offset:1024 nt lds
    v_mfma_f32_32x32x16_bf16 v[64:79], v[168:171], v[128:131], v[64:79]
    s_add_u32 m0, s54, 8192
    s_nop 0
    buffer_load_dwordx4 v5, s[20:23], s58 offen nt lds
    v_mfma_f32_32x32x16_bf16 v[80:95], v[172:175], v[128:131], v[80:95]
    buffer_load_dwordx4 v5, s[20:23], s58 offen offset:1024 nt lds
    v_mfma_f32_32x32x16_bf16 v[32:47], v[176:179], v[132:135], v[32:47]
    v_add_u32 v24, 98304, v10
    v_xor_b32 v25, 64, v24
    v_xor_b32 v26, 128, v24
    v_xor_b32 v27, 192, v24
    v_mfma_f32_32x32x16_bf16 v[48:63], v[180:183], v[132:135], v[48:63]
    ds_read_b64_tr_b16 v[160:161], v24 offset:0
    ds_read_b64_tr_b16 v[162:163], v24 offset:2048
    v_mfma_f32_32x32x16_bf16 v[64:79], v[184:187], v[132:135], v[64:79]
    ds_read_b64_tr_b16 v[164:165], v25 offset:0
    ds_read_b64_tr_b16 v[166:167], v25 offset:2048
    v_mfma_f32_32x32x16_bf16 v[80:95], v[188:191], v[132:135], v[80:95]
    ds_read_b64_tr_b16 v[168:169], v26 offset:0
    ds_read_b64_tr_b16 v[170:171], v26 offset:2048
    s_waitcnt lgkmcnt(13)
    v_mfma_f32_32x32x16_bf16 v[128:143], v[192:195], v[96:99], v[144:159]
    ds_read_b64_tr_b16 v[172:173], v27 offset:0
    ds_read_b64_tr_b16 v[174:175], v27 offset:2048
    s_waitcnt lgkmcnt(14)
    v_mfma_f32_32x32x16_bf16 v[128:143], v[196:199], v[100:103], v[128:143]
    ds_read_b64_tr_b16 v[176:177], v24 offset:4096
    ds_read_b64_tr_b16 v[178:179], v24 offset:6144
    s_waitcnt lgkmcnt(15)
    v_mfma_f32_32x32x16_bf16 v[128:143], v[200:203], v[104:107], v[128:143]
    ds_read_b64_tr_b16 v[180:181], v25 offset:4096
    ds_read_b64_tr_b16 v[182:183], v25 offset:6144
    s_waitcnt lgkmcnt(15)
    v_mfma_f32_32x32x16_bf16 v[128:143], v[204:207], v[108:111], v[128:143]
    ds_read_b64_tr_b16 v[184:185], v26 offset:4096
    ds_read_b64_tr_b16 v[186:187], v26 offset:6144
    v_mfma_f32_32x32x16_bf16 v[128:143], v[208:211], v[112:115], v[128:143]
    ds_read_b64_tr_b16 v[188:189], v27 offset:4096
    ds_read_b64_tr_b16 v[190:191], v27 offset:6144
    s_waitcnt lgkmcnt(15)
    v_mfma_f32_32x32x16_bf16 v[128:143], v[212:215], v[116:119], v[128:143]
    v_mfma_f32_32x32x16_bf16 v[128:143], v[216:219], v[120:123], v[128:143]
    v_mfma_f32_32x32x16_bf16 v[128:143], v[220:223], v[124:127], v[128:143]
    s_waitcnt vmcnt(4)
    s_barrier
    v_add_u32 v16, 131072, v9
    v_xor_b32 v17, 32, v16
    v_xor_b32 v18, 64, v16
    v_xor_b32 v19, 96, v16
    v_xor_b32 v20, 128, v16
    v_xor_b32 v21, 160, v16
    v_xor_b32 v22, 192, v16
    v_xor_b32 v23, 224, v16
    s_nop 2
    v_exp_f32 v128, v128
    v_exp_f32 v129, v129
    v_exp_f32 v130, v130
    v_exp_f32 v131, v131
    v_add_f32 v15, v128, v129
    v_exp_f32 v132, v132
    v_add_f32 v31, v130, v131
    v_exp_f32 v133, v133
    v_add_f32 v15, v15, v132
    v_exp_f32 v134, v134
    v_add_f32 v31, v31, v133
    v_exp_f32 v135, v135
    v_add_f32 v15, v15, v134
    v_exp_f32 v136, v136
    v_add_f32 v31, v31, v135
    v_exp_f32 v137, v137
    v_add_f32 v15, v15, v136
    v_exp_f32 v138, v138
    v_add_f32 v31, v31, v137
    v_exp_f32 v139, v139
    v_add_f32 v15, v15, v138
    v_exp_f32 v140, v140
    v_add_f32 v31, v31, v139
    v_exp_f32 v141, v141
    v_add_f32 v15, v15, v140
    v_exp_f32 v142, v142
    v_add_f32 v31, v31, v141
    v_exp_f32 v143, v143
    v_add_f32 v15, v15, v142
    v_add_f32 v15, v15, v31
    v_add_f32 v15, v15, v143
    v_cmp_lt_f32 vcc, s43, v15
    s_cbranch_vccnz SLOWS5
SLOWR5:
    ds_read_b128 v[192:195], v16
    ds_read_b128 v[196:199], v17
    ds_read_b128 v[200:203], v18
    ds_read_b128 v[204:207], v19
    ds_read_b128 v[208:211], v20
    ds_read_b128 v[212:215], v21
    ds_read_b128 v[216:219], v22
    ds_read_b128 v[220:223], v23
    v_add_f32 v13, v13, v15
    v_cvt_pk_bf16_f32 v128, v128, v129
    v_cvt_pk_bf16_f32 v129, v130, v131
    v_cvt_pk_bf16_f32 v130, v132, v133
    v_cvt_pk_bf16_f32 v131, v134, v135
    v_cvt_pk_bf16_f32 v132, v136, v137
    v_cvt_pk_bf16_f32 v133, v138, v139
    v_cvt_pk_bf16_f32 v134, v140, v141
    v_cvt_pk_bf16_f32 v135, v142, v143
    s_waitcnt lgkmcnt(8)
    s_barrier
    v_mfma_f32_32x32x16_bf16 v[32:47], v[160:163], v[128:131], v[32:47]
    s_add_u32 m0, s54, 32768
    s_mov_b32 s58, 65536
    buffer_load_dwordx4 v3, s[16:19], s58 offen nt lds
    v_mfma_f32_32x32x16_bf16 v[48:63], v[164:167], v[128:131], v[48:63]
    buffer_load_dwordx4 v4, s[16:19], s58 offen offset:1024 nt lds
    v_mfma_f32_32x32x16_bf16 v[64:79], v[168:171], v[128:131], v[64:79]
    s_add_u32 m0, s54, 40960
    s_nop 0
    buffer_load_dwordx4 v5, s[20:23], s58 offen nt lds
    v_mfma_f32_32x32x16_bf16 v[80:95], v[172:175], v[128:131], v[80:95]
    buffer_load_dwordx4 v5, s[20:23], s58 offen offset:1024 nt lds
    v_mfma_f32_32x32x16_bf16 v[32:47], v[176:179], v[132:135], v[32:47]
    v_add_u32 v24, 131072, v10
    v_xor_b32 v25, 64, v24
    v_xor_b32 v26, 128, v24
    v_xor_b32 v27, 192, v24
    v_mfma_f32_32x32x16_bf16 v[48:63], v[180:183], v[132:135], v[48:63]
    ds_read_b64_tr_b16 v[160:161], v24 offset:0
    ds_read_b64_tr_b16 v[162:163], v24 offset:2048
    v_mfma_f32_32x32x16_bf16 v[64:79], v[184:187], v[132:135], v[64:79]
    ds_read_b64_tr_b16 v[164:165], v25 offset:0
    ds_read_b64_tr_b16 v[166:167], v25 offset:2048
    v_mfma_f32_32x32x16_bf16 v[80:95], v[188:191], v[132:135], v[80:95]
    ds_read_b64_tr_b16 v[168:169], v26 offset:0
    ds_read_b64_tr_b16 v[170:171], v26 offset:2048
    s_waitcnt lgkmcnt(13)
    v_mfma_f32_32x32x16_bf16 v[128:143], v[192:195], v[96:99], v[144:159]
    ds_read_b64_tr_b16 v[172:173], v27 offset:0
    ds_read_b64_tr_b16 v[174:175], v27 offset:2048
    s_waitcnt lgkmcnt(14)
    v_mfma_f32_32x32x16_bf16 v[128:143], v[196:199], v[100:103], v[128:143]
    ds_read_b64_tr_b16 v[176:177], v24 offset:4096
    ds_read_b64_tr_b16 v[178:179], v24 offset:6144
    s_waitcnt lgkmcnt(15)
    v_mfma_f32_32x32x16_bf16 v[128:143], v[200:203], v[104:107], v[128:143]
    ds_read_b64_tr_b16 v[180:181], v25 offset:4096
    ds_read_b64_tr_b16 v[182:183], v25 offset:6144
    s_waitcnt lgkmcnt(15)
    v_mfma_f32_32x32x16_bf16 v[128:143], v[204:207], v[108:111], v[128:143]
    ds_read_b64_tr_b16 v[184:185], v26 offset:4096
    ds_read_b64_tr_b16 v[186:187], v26 offset:6144
    v_mfma_f32_32x32x16_bf16 v[128:143], v[208:211], v[112:115], v[128:143]
    ds_read_b64_tr_b16 v[188:189], v27 offset:4096
    ds_read_b64_tr_b16 v[190:191], v27 offset:6144
    s_waitcnt lgkmcnt(15)
    v_mfma_f32_32x32x16_bf16 v[128:143], v[212:215], v[116:119], v[128:143]
    v_mfma_f32_32x32x16_bf16 v[128:143], v[216:219], v[120:123], v[128:143]
    v_mfma_f32_32x32x16_bf16 v[128:143], v[220:223], v[124:127], v[128:143]
    s_waitcnt vmcnt(4)
    s_barrier
    v_add_u32 v16, 0, v9
    v_xor_b32 v17, 32, v16
    v_xor_b32 v18, 64, v16
    v_xor_b32 v19, 96, v16
    v_xor_b32 v20, 128, v16
    v_xor_b32 v21, 160, v16
    v_xor_b32 v22, 192, v16
    v_xor_b32 v23, 224, v16
    s_nop 2
    v_exp_f32 v128, v128
    v_exp_f32 v129, v129
    v_exp_f32 v130, v130
    v_exp_f32 v131, v131
    v_add_f32 v15, v128, v129
    v_exp_f32 v132, v132
    v_add_f32 v31, v130, v131
    v_exp_f32 v133, v133
    v_add_f32 v15, v15, v132
    v_exp_f32 v134, v134
    v_add_f32 v31, v31, v133
    v_exp_f32 v135, v135
    v_add_f32 v15, v15, v134
    v_exp_f32 v136, v136
    v_add_f32 v31, v31, v135
    v_exp_f32 v137, v137
    v_add_f32 v15, v15, v136
    v_exp_f32 v138, v138
    v_add_f32 v31, v31, v137
    v_exp_f32 v139, v139
    v_add_f32 v15, v15, v138
    v_exp_f32 v140, v140
    v_add_f32 v31, v31, v139
    v_exp_f32 v141, v141
    v_add_f32 v15, v15, v140
    v_exp_f32 v142, v142
    v_add_f32 v31, v31, v141
    v_exp_f32 v143, v143
    v_add_f32 v15, v15, v142
    v_add_f32 v15, v15, v31
    v_add_f32 v15, v15, v143
    v_cmp_lt_f32 vcc, s43, v15
    s_cbranch_vccnz SLOWS6
SLOWR6:
    ds_read_b128 v[192:195], v16
    ds_read_b128 v[196:199], v17
    ds_read_b128 v[200:203], v18
    ds_read_b128 v[204:207], v19
    ds_read_b128 v[208:211], v20
    ds_read_b128 v[212:215], v21
    ds_read_b128 v[216:219], v22
    ds_read_b128 v[220:223], v23
    v_add_f32 v13, v13, v15
    v_cvt_pk_bf16_f32 v128, v128, v129
    v_cvt_pk_bf16_f32 v129, v130, v131
    v_cvt_pk_bf16_f32 v130, v132, v133
    v_cvt_pk_bf16_f32 v131, v134, v135
    v_cvt_pk_bf16_f32 v132, v136, v137
    v_cvt_pk_bf16_f32 v133, v138, v139
    v_cvt_pk_bf16_f32 v134, v140, v141
    v_cvt_pk_bf16_f32 v135, v142, v143
    s_waitcnt lgkmcnt(8)
    s_barrier
    v_mfma_f32_32x32x16_bf16 v[32:47], v[160:163], v[128:131], v[32:47]
    s_add_u32 m0, s54, 65536
    s_mov_b32 s58, 73728
    buffer_load_dwordx4 v3, s[16:19], s58 offen nt lds
    v_mfma_f32_32x32x16_bf16 v[48:63], v[164:167], v[128:131], v[48:63]
    buffer_load_dwordx4 v4, s[16:19], s58 offen offset:1024 nt lds
    v_mfma_f32_32x32x16_bf16 v[64:79], v[168:171], v[128:131], v[64:79]
    s_add_u32 m0, s54, 73728
    s_nop 0
    buffer_load_dwordx4 v5, s[20:23], s58 offen nt lds
    v_mfma_f32_32x32x16_bf16 v[80:95], v[172:175], v[128:131], v[80:95]
    buffer_load_dwordx4 v5, s[20:23], s58 offen offset:1024 nt lds
    v_mfma_f32_32x32x16_bf16 v[32:47], v[176:179], v[132:135], v[32:47]
    v_add_u32 v24, 0, v10
    v_xor_b32 v25, 64, v24
    v_xor_b32 v26, 128, v24
    v_xor_b32 v27, 192, v24
    v_mfma_f32_32x32x16_bf16 v[48:63], v[180:183], v[132:135], v[48:63]
    ds_read_b64_tr_b16 v[160:161], v24 offset:0
    ds_read_b64_tr_b16 v[162:163], v24 offset:2048
    v_mfma_f32_32x32x16_bf16 v[64:79], v[184:187], v[132:135], v[64:79]
    ds_read_b64_tr_b16 v[164:165], v25 offset:0
    ds_read_b64_tr_b16 v[166:167], v25 offset:2048
    v_mfma_f32_32x32x16_bf16 v[80:95], v[188:191], v[132:135], v[80:95]
    ds_read_b64_tr_b16 v[168:169], v26 offset:0
    ds_read_b64_tr_b16 v[170:171], v26 offset:2048
    s_waitcnt lgkmcnt(13)
    v_mfma_f32_32x32x16_bf16 v[128:143], v[192:195], v[96:99], v[144:159]
    ds_read_b64_tr_b16 v[172:173], v27 offset:0
    ds_read_b64_tr_b16 v[174:175], v27 offset:2048
    s_waitcnt lgkmcnt(14)
    v_mfma_f32_32x32x16_bf16 v[128:143], v[196:199], v[100:103], v[128:143]
    ds_read_b64_tr_b16 v[176:177], v24 offset:4096
    ds_read_b64_tr_b16 v[178:179], v24 offset:6144
    s_waitcnt lgkmcnt(15)
    v_mfma_f32_32x32x16_bf16 v[128:143], v[200:203], v[104:107], v[128:143]
    ds_read_b64_tr_b16 v[180:181], v25 offset:4096
    ds_read_b64_tr_b16 v[182:183], v25 offset:6144
    s_waitcnt lgkmcnt(15)
    v_mfma_f32_32x32x16_bf16 v[128:143], v[204:207], v[108:111], v[128:143]
    ds_read_b64_tr_b16 v[184:185], v26 offset:4096
    ds_read_b64_tr_b16 v[186:187], v26 offset:6144
    v_mfma_f32_32x32x16_bf16 v[128:143], v[208:211], v[112:115], v[128:143]
    ds_read_b64_tr_b16 v[188:189], v27 offset:4096
    ds_read_b64_tr_b16 v[190:191], v27 offset:6144
    s_waitcnt lgkmcnt(15)
    v_mfma_f32_32x32x16_bf16 v[128:143], v[212:215], v[116:119], v[128:143]
    v_mfma_f32_32x32x16_bf16 v[128:143], v[216:219], v[120:123], v[128:143]
    v_mfma_f32_32x32x16_bf16 v[128:143], v[220:223], v[124:127], v[128:143]
    s_waitcnt vmcnt(4)
    s_barrier
    v_add_u32 v16, 32768, v9
    v_xor_b32 v17, 32, v16
    v_xor_b32 v18, 64, v16
    v_xor_b32 v19, 96, v16
    v_xor_b32 v20, 128, v16
    v_xor_b32 v21, 160, v16
    v_xor_b32 v22, 192, v16
    v_xor_b32 v23, 224, v16
    s_nop 2
    v_exp_f32 v128, v128
    v_exp_f32 v129, v129
    v_exp_f32 v130, v130
    v_exp_f32 v131, v131
    v_add_f32 v15, v128, v129
    v_exp_f32 v132, v132
    v_add_f32 v31, v130, v131
    v_exp_f32 v133, v133
    v_add_f32 v15, v15, v132
    v_exp_f32 v134, v134
    v_add_f32 v31, v31, v133
    v_exp_f32 v135, v135
    v_add_f32 v15, v15, v134
    v_exp_f32 v136, v136
    v_add_f32 v31, v31, v135
    v_exp_f32 v137, v137
    v_add_f32 v15, v15, v136
    v_exp_f32 v138, v138
    v_add_f32 v31, v31, v137
    v_exp_f32 v139, v139
    v_add_f32 v15, v15, v138
    v_exp_f32 v140, v140
    v_add_f32 v31, v31, v139
    v_exp_f32 v141, v141
    v_add_f32 v15, v15, v140
    v_exp_f32 v142, v142
    v_add_f32 v31, v31, v141
    v_exp_f32 v143, v143
    v_add_f32 v15, v15, v142
    v_add_f32 v15, v15, v31
    v_add_f32 v15, v15, v143
    v_cmp_lt_f32 vcc, s43, v15
    s_cbranch_vccnz SLOWS7
SLOWR7:
    ds_read_b128 v[192:195], v16
    ds_read_b128 v[196:199], v17
    ds_read_b128 v[200:203], v18
    ds_read_b128 v[204:207], v19
    ds_read_b128 v[208:211], v20
    ds_read_b128 v[212:215], v21
    ds_read_b128 v[216:219], v22
    ds_read_b128 v[220:223], v23
    v_add_f32 v13, v13, v15
    v_cvt_pk_bf16_f32 v128, v128, v129
    v_cvt_pk_bf16_f32 v129, v130, v131
    v_cvt_pk_bf16_f32 v130, v132, v133
    v_cvt_pk_bf16_f32 v131, v134, v135
    v_cvt_pk_bf16_f32 v132, v136, v137
    v_cvt_pk_bf16_f32 v133, v138, v139
    v_cvt_pk_bf16_f32 v134, v140, v141
    v_cvt_pk_bf16_f32 v135, v142, v143
    s_waitcnt lgkmcnt(8)
    s_barrier
    v_mfma_f32_32x32x16_bf16 v[32:47], v[160:163], v[128:131], v[32:47]
    s_add_u32 m0, s54, 98304
    s_mov_b32 s58, 81920
    buffer_load_dwordx4 v3, s[16:19], s58 offen nt lds
    v_mfma_f32_32x32x16_bf16 v[48:63], v[164:167], v[128:131], v[48:63]
    buffer_load_dwordx4 v4, s[16:19], s58 offen offset:1024 nt lds
    v_mfma_f32_32x32x16_bf16 v[64:79], v[168:171], v[128:131], v[64:79]
    s_add_u32 m0, s54, 106496
    s_nop 0
    buffer_load_dwordx4 v5, s[20:23], s58 offen nt lds
    v_mfma_f32_32x32x16_bf16 v[80:95], v[172:175], v[128:131], v[80:95]
    buffer_load_dwordx4 v5, s[20:23], s58 offen offset:1024 nt lds
    v_mfma_f32_32x32x16_bf16 v[32:47], v[176:179], v[132:135], v[32:47]
    v_add_u32 v24, 32768, v10
    v_xor_b32 v25, 64, v24
    v_xor_b32 v26, 128, v24
    v_xor_b32 v27, 192, v24
    v_mfma_f32_32x32x16_bf16 v[48:63], v[180:183], v[132:135], v[48:63]
    ds_read_b64_tr_b16 v[160:161], v24 offset:0
    ds_read_b64_tr_b16 v[162:163], v24 offset:2048
    v_mfma_f32_32x32x16_bf16 v[64:79], v[184:187], v[132:135], v[64:79]
    ds_read_b64_tr_b16 v[164:165], v25 offset:0
    ds_read_b64_tr_b16 v[166:167], v25 offset:2048
    v_mfma_f32_32x32x16_bf16 v[80:95], v[188:191], v[132:135], v[80:95]
    ds_read_b64_tr_b16 v[168:169], v26 offset:0
    ds_read_b64_tr_b16 v[170:171], v26 offset:2048
    s_waitcnt lgkmcnt(13)
    v_mfma_f32_32x32x16_bf16 v[128:143], v[192:195], v[96:99], v[144:159]
    ds_read_b64_tr_b16 v[172:173], v27 offset:0
    ds_read_b64_tr_b16 v[174:175], v27 offset:2048
    s_waitcnt lgkmcnt(14)
    v_mfma_f32_32x32x16_bf16 v[128:143], v[196:199], v[100:103], v[128:143]
    ds_read_b64_tr_b16 v[176:177], v24 offset:4096
    ds_read_b64_tr_b16 v[178:179], v24 offset:6144
    s_waitcnt lgkmcnt(15)
    v_mfma_f32_32x32x16_bf16 v[128:143], v[200:203], v[104:107], v[128:143]
    ds_read_b64_tr_b16 v[180:181], v25 offset:4096
    ds_read_b64_tr_b16 v[182:183], v25 offset:6144
    s_waitcnt lgkmcnt(15)
    v_mfma_f32_32x32x16_bf16 v[128:143], v[204:207], v[108:111], v[128:143]
    ds_read_b64_tr_b16 v[184:185], v26 offset:4096
    ds_read_b64_tr_b16 v[186:187], v26 offset:6144
    v_mfma_f32_32x32x16_bf16 v[128:143], v[208:211], v[112:115], v[128:143]
    ds_read_b64_tr_b16 v[188:189], v27 offset:4096
    ds_read_b64_tr_b16 v[190:191], v27 offset:6144
    s_waitcnt lgkmcnt(15)
    v_mfma_f32_32x32x16_bf16 v[128:143], v[212:215], v[116:119], v[128:143]
    v_mfma_f32_32x32x16_bf16 v[128:143], v[216:219], v[120:123], v[128:143]
    v_mfma_f32_32x32x16_bf16 v[128:143], v[220:223], v[124:127], v[128:143]
    s_waitcnt vmcnt(4)
    s_barrier
    v_add_u32 v16, 65536, v9
    v_xor_b32 v17, 32, v16
    v_xor_b32 v18, 64, v16
    v_xor_b32 v19, 96, v16
    v_xor_b32 v20, 128, v16
    v_xor_b32 v21, 160, v16
    v_xor_b32 v22, 192, v16
    v_xor_b32 v23, 224, v16
    s_nop 2
    v_exp_f32 v128, v128
    v_exp_f32 v129, v129
    v_exp_f32 v130, v130
    v_exp_f32 v131, v131
    v_add_f32 v15, v128, v129
    v_exp_f32 v132, v132
    v_add_f32 v31, v130, v131
    v_exp_f32 v133, v133
    v_add_f32 v15, v15, v132
    v_exp_f32 v134, v134
    v_add_f32 v31, v31, v133
    v_exp_f32 v135, v135
    v_add_f32 v15, v15, v134
    v_exp_f32 v136, v136
    v_add_f32 v31, v31, v135
    v_exp_f32 v137, v137
    v_add_f32 v15, v15, v136
    v_exp_f32 v138, v138
    v_add_f32 v31, v31, v137
    v_exp_f32 v139, v139
    v_add_f32 v15, v15, v138
    v_exp_f32 v140, v140
    v_add_f32 v31, v31, v139
    v_exp_f32 v141, v141
    v_add_f32 v15, v15, v140
    v_exp_f32 v142, v142
    v_add_f32 v31, v31, v141
    v_exp_f32 v143, v143
    v_add_f32 v15, v15, v142
    v_add_f32 v15, v15, v31
    v_add_f32 v15, v15, v143
    v_cmp_lt_f32 vcc, s43, v15
    s_cbranch_vccnz SLOWS8
SLOWR8:
    ds_read_b128 v[192:195], v16
    ds_read_b128 v[196:199], v17
    ds_read_b128 v[200:203], v18
    ds_read_b128 v[204:207], v19
    ds_read_b128 v[208:211], v20
    ds_read_b128 v[212:215], v21
    ds_read_b128 v[216:219], v22
    ds_read_b128 v[220:223], v23
    v_add_f32 v13, v13, v15
    v_cvt_pk_bf16_f32 v128, v128, v129
    v_cvt_pk_bf16_f32 v129, v130, v131
    v_cvt_pk_bf16_f32 v130, v132, v133
    v_cvt_pk_bf16_f32 v131, v134, v135
    v_cvt_pk_bf16_f32 v132, v136, v137
    v_cvt_pk_bf16_f32 v133, v138, v139
    v_cvt_pk_bf16_f32 v134, v140, v141
    v_cvt_pk_bf16_f32 v135, v142, v143
    s_waitcnt lgkmcnt(8)
    s_barrier
    v_mfma_f32_32x32x16_bf16 v[32:47], v[160:163], v[128:131], v[32:47]
    s_add_u32 m0, s54, 131072
    s_mov_b32 s58, 90112
    buffer_load_dwordx4 v3, s[16:19], s58 offen nt lds
    v_mfma_f32_32x32x16_bf16 v[48:63], v[164:167], v[128:131], v[48:63]
    buffer_load_dwordx4 v4, s[16:19], s58 offen offset:1024 nt lds
    v_mfma_f32_32x32x16_bf16 v[64:79], v[168:171], v[128:131], v[64:79]
    s_add_u32 m0, s54, 139264
    s_nop 0
    buffer_load_dwordx4 v5, s[20:23], s58 offen nt lds
    v_mfma_f32_32x32x16_bf16 v[80:95], v[172:175], v[128:131], v[80:95]
    buffer_load_dwordx4 v5, s[20:23], s58 offen offset:1024 nt lds
    v_mfma_f32_32x32x16_bf16 v[32:47], v[176:179], v[132:135], v[32:47]
    v_add_u32 v24, 65536, v10
    v_xor_b32 v25, 64, v24
    v_xor_b32 v26, 128, v24
    v_xor_b32 v27, 192, v24
    v_mfma_f32_32x32x16_bf16 v[48:63], v[180:183], v[132:135], v[48:63]
    ds_read_b64_tr_b16 v[160:161], v24 offset:0
    ds_read_b64_tr_b16 v[162:163], v24 offset:2048
    v_mfma_f32_32x32x16_bf16 v[64:79], v[184:187], v[132:135], v[64:79]
    ds_read_b64_tr_b16 v[164:165], v25 offset:0
    ds_read_b64_tr_b16 v[166:167], v25 offset:2048
    v_mfma_f32_32x32x16_bf16 v[80:95], v[188:191], v[132:135], v[80:95]
    ds_read_b64_tr_b16 v[168:169], v26 offset:0
    ds_read_b64_tr_b16 v[170:171], v26 offset:2048
    s_waitcnt lgkmcnt(13)
    v_mfma_f32_32x32x16_bf16 v[128:143], v[192:195], v[96:99], v[144:159]
    ds_read_b64_tr_b16 v[172:173], v27 offset:0
    ds_read_b64_tr_b16 v[174:175], v27 offset:2048
    s_waitcnt lgkmcnt(14)
    v_mfma_f32_32x32x16_bf16 v[128:143], v[196:199], v[100:103], v[128:143]
    ds_read_b64_tr_b16 v[176:177], v24 offset:4096
    ds_read_b64_tr_b16 v[178:179], v24 offset:6144
    s_waitcnt lgkmcnt(15)
    v_mfma_f32_32x32x16_bf16 v[128:143], v[200:203], v[104:107], v[128:143]
    ds_read_b64_tr_b16 v[180:181], v25 offset:4096
    ds_read_b64_tr_b16 v[182:183], v25 offset:6144
    s_waitcnt lgkmcnt(15)
    v_mfma_f32_32x32x16_bf16 v[128:143], v[204:207], v[108:111], v[128:143]
    ds_read_b64_tr_b16 v[184:185], v26 offset:4096
    ds_read_b64_tr_b16 v[186:187], v26 offset:6144
    v_mfma_f32_32x32x16_bf16 v[128:143], v[208:211], v[112:115], v[128:143]
    ds_read_b64_tr_b16 v[188:189], v27 offset:4096
    ds_read_b64_tr_b16 v[190:191], v27 offset:6144
    s_waitcnt lgkmcnt(15)
    v_mfma_f32_32x32x16_bf16 v[128:143], v[212:215], v[116:119], v[128:143]
    v_mfma_f32_32x32x16_bf16 v[128:143], v[216:219], v[120:123], v[128:143]
    v_mfma_f32_32x32x16_bf16 v[128:143], v[220:223], v[124:127], v[128:143]
    s_waitcnt vmcnt(4)
    s_barrier
    v_add_u32 v16, 98304, v9
    v_xor_b32 v17, 32, v16
    v_xor_b32 v18, 64, v16
    v_xor_b32 v19, 96, v16
    v_xor_b32 v20, 128, v16
    v_xor_b32 v21, 160, v16
    v_xor_b32 v22, 192, v16
    v_xor_b32 v23, 224, v16
    s_nop 2
    v_exp_f32 v128, v128
    v_exp_f32 v129, v129
    v_exp_f32 v130, v130
    v_exp_f32 v131, v131
    v_add_f32 v15, v128, v129
    v_exp_f32 v132, v132
    v_add_f32 v31, v130, v131
    v_exp_f32 v133, v133
    v_add_f32 v15, v15, v132
    v_exp_f32 v134, v134
    v_add_f32 v31, v31, v133
    v_exp_f32 v135, v135
    v_add_f32 v15, v15, v134
    v_exp_f32 v136, v136
    v_add_f32 v31, v31, v135
    v_exp_f32 v137, v137
    v_add_f32 v15, v15, v136
    v_exp_f32 v138, v138
    v_add_f32 v31, v31, v137
    v_exp_f32 v139, v139
    v_add_f32 v15, v15, v138
    v_exp_f32 v140, v140
    v_add_f32 v31, v31, v139
    v_exp_f32 v141, v141
    v_add_f32 v15, v15, v140
    v_exp_f32 v142, v142
    v_add_f32 v31, v31, v141
    v_exp_f32 v143, v143
    v_add_f32 v15, v15, v142
    v_add_f32 v15, v15, v31
    v_add_f32 v15, v15, v143
    v_cmp_lt_f32 vcc, s43, v15
    s_cbranch_vccnz SLOWS9
SLOWR9:
    ds_read_b128 v[192:195], v16
    ds_read_b128 v[196:199], v17
    ds_read_b128 v[200:203], v18
    ds_read_b128 v[204:207], v19
    ds_read_b128 v[208:211], v20
    ds_read_b128 v[212:215], v21
    ds_read_b128 v[216:219], v22
    ds_read_b128 v[220:223], v23
    v_add_f32 v13, v13, v15
    v_cvt_pk_bf16_f32 v128, v128, v129
    v_cvt_pk_bf16_f32 v129, v130, v131
    v_cvt_pk_bf16_f32 v130, v132, v133
    v_cvt_pk_bf16_f32 v131, v134, v135
    v_cvt_pk_bf16_f32 v132, v136, v137
    v_cvt_pk_bf16_f32 v133, v138, v139
    v_cvt_pk_bf16_f32 v134, v140, v141
    v_cvt_pk_bf16_f32 v135, v142, v143
    s_waitcnt lgkmcnt(8)
    s_barrier
    v_mfma_f32_32x32x16_bf16 v[32:47], v[160:163], v[128:131], v[32:47]
    s_add_u32 m0, s54, 0
    s_mov_b32 s58, 98304
    buffer_load_dwordx4 v3, s[16:19], s58 offen nt lds
    v_mfma_f32_32x32x16_bf16 v[48:63], v[164:167], v[128:131], v[48:63]
    buffer_load_dwordx4 v4, s[16:19], s58 offen offset:1024 nt lds
    v_mfma_f32_32x32x16_bf16 v[64:79], v[168:171], v[128:131], v[64:79]
    s_add_u32 m0, s54, 8192
    s_nop 0
    buffer_load_dwordx4 v5, s[20:23], s58 offen nt lds
    v_mfma_f32_32x32x16_bf16 v[80:95], v[172:175], v[128:131], v[80:95]
    buffer_load_dwordx4 v5, s[20:23], s58 offen offset:1024 nt lds
    v_mfma_f32_32x32x16_bf16 v[32:47], v[176:179], v[132:135], v[32:47]
    v_add_u32 v24, 98304, v10
    v_xor_b32 v25, 64, v24
    v_xor_b32 v26, 128, v24
    v_xor_b32 v27, 192, v24
    v_mfma_f32_32x32x16_bf16 v[48:63], v[180:183], v[132:135], v[48:63]
    ds_read_b64_tr_b16 v[160:161], v24 offset:0
    ds_read_b64_tr_b16 v[162:163], v24 offset:2048
    v_mfma_f32_32x32x16_bf16 v[64:79], v[184:187], v[132:135], v[64:79]
    ds_read_b64_tr_b16 v[164:165], v25 offset:0
    ds_read_b64_tr_b16 v[166:167], v25 offset:2048
    v_mfma_f32_32x32x16_bf16 v[80:95], v[188:191], v[132:135], v[80:95]
    ds_read_b64_tr_b16 v[168:169], v26 offset:0
    ds_read_b64_tr_b16 v[170:171], v26 offset:2048
    s_waitcnt lgkmcnt(13)
    v_mfma_f32_32x32x16_bf16 v[128:143], v[192:195], v[96:99], v[144:159]
    ds_read_b64_tr_b16 v[172:173], v27 offset:0
    ds_read_b64_tr_b16 v[174:175], v27 offset:2048
    s_waitcnt lgkmcnt(14)
    v_mfma_f32_32x32x16_bf16 v[128:143], v[196:199], v[100:103], v[128:143]
    ds_read_b64_tr_b16 v[176:177], v24 offset:4096
    ds_read_b64_tr_b16 v[178:179], v24 offset:6144
    s_waitcnt lgkmcnt(15)
    v_mfma_f32_32x32x16_bf16 v[128:143], v[200:203], v[104:107], v[128:143]
    ds_read_b64_tr_b16 v[180:181], v25 offset:4096
    ds_read_b64_tr_b16 v[182:183], v25 offset:6144
    s_waitcnt lgkmcnt(15)
    v_mfma_f32_32x32x16_bf16 v[128:143], v[204:207], v[108:111], v[128:143]
    ds_read_b64_tr_b16 v[184:185], v26 offset:4096
    ds_read_b64_tr_b16 v[186:187], v26 offset:6144
    v_mfma_f32_32x32x16_bf16 v[128:143], v[208:211], v[112:115], v[128:143]
    ds_read_b64_tr_b16 v[188:189], v27 offset:4096
    ds_read_b64_tr_b16 v[190:191], v27 offset:6144
    s_waitcnt lgkmcnt(15)
    v_mfma_f32_32x32x16_bf16 v[128:143], v[212:215], v[116:119], v[128:143]
    v_mfma_f32_32x32x16_bf16 v[128:143], v[216:219], v[120:123], v[128:143]
    v_mfma_f32_32x32x16_bf16 v[128:143], v[220:223], v[124:127], v[128:143]
    s_waitcnt vmcnt(4)
    s_barrier
    v_add_u32 v16, 131072, v9
    v_xor_b32 v17, 32, v16
    v_xor_b32 v18, 64, v16
    v_xor_b32 v19, 96, v16
    v_xor_b32 v20, 128, v16
    v_xor_b32 v21, 160, v16
    v_xor_b32 v22, 192, v16
    v_xor_b32 v23, 224, v16
    s_nop 2
    v_exp_f32 v128, v128
    v_exp_f32 v129, v129
    v_exp_f32 v130, v130
    v_exp_f32 v131, v131
    v_add_f32 v15, v128, v129
    v_exp_f32 v132, v132
    v_add_f32 v31, v130, v131
    v_exp_f32 v133, v133
    v_add_f32 v15, v15, v132
    v_exp_f32 v134, v134
    v_add_f32 v31, v31, v133
    v_exp_f32 v135, v135
    v_add_f32 v15, v15, v134
    v_exp_f32 v136, v136
    v_add_f32 v31, v31, v135
    v_exp_f32 v137, v137
    v_add_f32 v15, v15, v136
    v_exp_f32 v138, v138
    v_add_f32 v31, v31, v137
    v_exp_f32 v139, v139
    v_add_f32 v15, v15, v138
    v_exp_f32 v140, v140
    v_add_f32 v31, v31, v139
    v_exp_f32 v141, v141
    v_add_f32 v15, v15, v140
    v_exp_f32 v142, v142
    v_add_f32 v31, v31, v141
    v_exp_f32 v143, v143
    v_add_f32 v15, v15, v142
    v_add_f32 v15, v15, v31
    v_add_f32 v15, v15, v143
    v_cmp_lt_f32 vcc, s43, v15
    s_cbranch_vccnz SLOWS10
SLOWR10:
    ds_read_b128 v[192:195], v16
    ds_read_b128 v[196:199], v17
    ds_read_b128 v[200:203], v18
    ds_read_b128 v[204:207], v19
    ds_read_b128 v[208:211], v20
    ds_read_b128 v[212:215], v21
    ds_read_b128 v[216:219], v22
    ds_read_b128 v[220:223], v23
    v_add_f32 v13, v13, v15
    v_cvt_pk_bf16_f32 v128, v128, v129
    v_cvt_pk_bf16_f32 v129, v130, v131
    v_cvt_pk_bf16_f32 v130, v132, v133
    v_cvt_pk_bf16_f32 v131, v134, v135
    v_cvt_pk_bf16_f32 v132, v136, v137
    v_cvt_pk_bf16_f32 v133, v138, v139
    v_cvt_pk_bf16_f32 v134, v140, v141
    v_cvt_pk_bf16_f32 v135, v142, v143
    s_waitcnt lgkmcnt(8)
    s_barrier
    v_mfma_f32_32x32x16_bf16 v[32:47], v[160:163], v[128:131], v[32:47]
    s_add_u32 m0, s54, 32768
    s_mov_b32 s58, 106496
    buffer_load_dwordx4 v3, s[16:19], s58 offen nt lds
    v_mfma_f32_32x32x16_bf16 v[48:63], v[164:167], v[128:131], v[48:63]
    buffer_load_dwordx4 v4, s[16:19], s58 offen offset:1024 nt lds
    v_mfma_f32_32x32x16_bf16 v[64:79], v[168:171], v[128:131], v[64:79]
    s_add_u32 m0, s54, 40960
    s_nop 0
    buffer_load_dwordx4 v5, s[20:23], s58 offen nt lds
    v_mfma_f32_32x32x16_bf16 v[80:95], v[172:175], v[128:131], v[80:95]
    buffer_load_dwordx4 v5, s[20:23], s58 offen offset:1024 nt lds
    v_mfma_f32_32x32x16_bf16 v[32:47], v[176:179], v[132:135], v[32:47]
    v_add_u32 v24, 131072, v10
    v_xor_b32 v25, 64, v24
    v_xor_b32 v26, 128, v24
    v_xor_b32 v27, 192, v24
    v_mfma_f32_32x32x16_bf16 v[48:63], v[180:183], v[132:135], v[48:63]
    ds_read_b64_tr_b16 v[160:161], v24 offset:0
    ds_read_b64_tr_b16 v[162:163], v24 offset:2048
    v_mfma_f32_32x32x16_bf16 v[64:79], v[184:187], v[132:135], v[64:79]
    ds_read_b64_tr_b16 v[164:165], v25 offset:0
    ds_read_b64_tr_b16 v[166:167], v25 offset:2048
    v_mfma_f32_32x32x16_bf16 v[80:95], v[188:191], v[132:135], v[80:95]
    ds_read_b64_tr_b16 v[168:169], v26 offset:0
    ds_read_b64_tr_b16 v[170:171], v26 offset:2048
    s_waitcnt lgkmcnt(13)
    v_mfma_f32_32x32x16_bf16 v[128:143], v[192:195], v[96:99], v[144:159]
    ds_read_b64_tr_b16 v[172:173], v27 offset:0
    ds_read_b64_tr_b16 v[174:175], v27 offset:2048
    s_waitcnt lgkmcnt(14)
    v_mfma_f32_32x32x16_bf16 v[128:143], v[196:199], v[100:103], v[128:143]
    ds_read_b64_tr_b16 v[176:177], v24 offset:4096
    ds_read_b64_tr_b16 v[178:179], v24 offset:6144
    s_waitcnt lgkmcnt(15)
    v_mfma_f32_32x32x16_bf16 v[128:143], v[200:203], v[104:107], v[128:143]
    ds_read_b64_tr_b16 v[180:181], v25 offset:4096
    ds_read_b64_tr_b16 v[182:183], v25 offset:6144
    s_waitcnt lgkmcnt(15)
    v_mfma_f32_32x32x16_bf16 v[128:143], v[204:207], v[108:111], v[128:143]
    ds_read_b64_tr_b16 v[184:185], v26 offset:4096
    ds_read_b64_tr_b16 v[186:187], v26 offset:6144
    v_mfma_f32_32x32x16_bf16 v[128:143], v[208:211], v[112:115], v[128:143]
    ds_read_b64_tr_b16 v[188:189], v27 offset:4096
    ds_read_b64_tr_b16 v[190:191], v27 offset:6144
    s_waitcnt lgkmcnt(15)
    v_mfma_f32_32x32x16_bf16 v[128:143], v[212:215], v[116:119], v[128:143]
    v_mfma_f32_32x32x16_bf16 v[128:143], v[216:219], v[120:123], v[128:143]
    v_mfma_f32_32x32x16_bf16 v[128:143], v[220:223], v[124:127], v[128:143]
    s_waitcnt vmcnt(4)
    s_barrier
    v_add_u32 v16, 0, v9
    v_xor_b32 v17, 32, v16
    v_xor_b32 v18, 64, v16
    v_xor_b32 v19, 96, v16
    v_xor_b32 v20, 128, v16
    v_xor_b32 v21, 160, v16
    v_xor_b32 v22, 192, v16
    v_xor_b32 v23, 224, v16
    s_nop 2
    v_exp_f32 v128, v128
    v_exp_f32 v129, v129
    v_exp_f32 v130, v130
    v_exp_f32 v131, v131
    v_add_f32 v15, v128, v129
    v_exp_f32 v132, v132
    v_add_f32 v31, v130, v131
    v_exp_f32 v133, v133
    v_add_f32 v15, v15, v132
    v_exp_f32 v134, v134
    v_add_f32 v31, v31, v133
    v_exp_f32 v135, v135
    v_add_f32 v15, v15, v134
    v_exp_f32 v136, v136
    v_add_f32 v31, v31, v135
    v_exp_f32 v137, v137
    v_add_f32 v15, v15, v136
    v_exp_f32 v138, v138
    v_add_f32 v31, v31, v137
    v_exp_f32 v139, v139
    v_add_f32 v15, v15, v138
    v_exp_f32 v140, v140
    v_add_f32 v31, v31, v139
    v_exp_f32 v141, v141
    v_add_f32 v15, v15, v140
    v_exp_f32 v142, v142
    v_add_f32 v31, v31, v141
    v_exp_f32 v143, v143
    v_add_f32 v15, v15, v142
    v_add_f32 v15, v15, v31
    v_add_f32 v15, v15, v143
    v_cmp_lt_f32 vcc, s43, v15
    s_cbranch_vccnz SLOWS11
SLOWR11:
    ds_read_b128 v[192:195], v16
    ds_read_b128 v[196:199], v17
    ds_read_b128 v[200:203], v18
    ds_read_b128 v[204:207], v19
    ds_read_b128 v[208:211], v20
    ds_read_b128 v[212:215], v21
    ds_read_b128 v[216:219], v22
    ds_read_b128 v[220:223], v23
    v_add_f32 v13, v13, v15
    v_cvt_pk_bf16_f32 v128, v128, v129
    v_cvt_pk_bf16_f32 v129, v130, v131
    v_cvt_pk_bf16_f32 v130, v132, v133
    v_cvt_pk_bf16_f32 v131, v134, v135
    v_cvt_pk_bf16_f32 v132, v136, v137
    v_cvt_pk_bf16_f32 v133, v138, v139
    v_cvt_pk_bf16_f32 v134, v140, v141
    v_cvt_pk_bf16_f32 v135, v142, v143
    s_waitcnt lgkmcnt(8)
    s_barrier
    v_mfma_f32_32x32x16_bf16 v[32:47], v[160:163], v[128:131], v[32:47]
    s_add_u32 m0, s54, 65536
    s_mov_b32 s58, 114688
    buffer_load_dwordx4 v3, s[16:19], s58 offen nt lds
    v_mfma_f32_32x32x16_bf16 v[48:63], v[164:167], v[128:131], v[48:63]
    buffer_load_dwordx4 v4, s[16:19], s58 offen offset:1024 nt lds
    v_mfma_f32_32x32x16_bf16 v[64:79], v[168:171], v[128:131], v[64:79]
    s_add_u32 m0, s54, 73728
    s_nop 0
    buffer_load_dwordx4 v5, s[20:23], s58 offen nt lds
    v_mfma_f32_32x32x16_bf16 v[80:95], v[172:175], v[128:131], v[80:95]
    buffer_load_dwordx4 v5, s[20:23], s58 offen offset:1024 nt lds
    v_mfma_f32_32x32x16_bf16 v[32:47], v[176:179], v[132:135], v[32:47]
    s_add_u32 m0, s55, 131072
    s_mov_b32 s58, 0
    buffer_load_dwordx4 v6, s[24:27], 0 offen lds
    v_add_u32 v24, 0, v10
    v_xor_b32 v25, 64, v24
    v_xor_b32 v26, 128, v24
    v_xor_b32 v27, 192, v24
    v_mfma_f32_32x32x16_bf16 v[48:63], v[180:183], v[132:135], v[48:63]
    buffer_load_dwordx4 v28, s[24:27], 0 offen offset:1024 lds
    ds_read_b64_tr_b16 v[160:161], v24 offset:0
    ds_read_b64_tr_b16 v[162:163], v24 offset:2048
    v_mfma_f32_32x32x16_bf16 v[64:79], v[184:187], v[132:135], v[64:79]
    buffer_load_dwordx4 v29, s[24:27], 0 offen offset:2048 lds
    ds_read_b64_tr_b16 v[164:165], v25 offset:0
    ds_read_b64_tr_b16 v[166:167], v25 offset:2048
    v_mfma_f32_32x32x16_bf16 v[80:95], v[188:191], v[132:135], v[80:95]
    buffer_load_dwordx4 v30, s[24:27], 0 offen offset:3072 lds
    ds_read_b64_tr_b16 v[168:169], v26 offset:0
    ds_read_b64_tr_b16 v[170:171], v26 offset:2048
    s_waitcnt lgkmcnt(13)
    v_mfma_f32_32x32x16_bf16 v[128:143], v[192:195], v[96:99], v[144:159]
    ds_read_b64_tr_b16 v[172:173], v27 offset:0
    ds_read_b64_tr_b16 v[174:175], v27 offset:2048
    s_waitcnt lgkmcnt(14)
    v_mfma_f32_32x32x16_bf16 v[128:143], v[196:199], v[100:103], v[128:143]
    ds_read_b64_tr_b16 v[176:177], v24 offset:4096
    ds_read_b64_tr_b16 v[178:179], v24 offset:6144
    s_waitcnt lgkmcnt(15)
    v_mfma_f32_32x32x16_bf16 v[128:143], v[200:203], v[104:107], v[128:143]
    ds_read_b64_tr_b16 v[180:181], v25 offset:4096
    ds_read_b64_tr_b16 v[182:183], v25 offset:6144
    s_waitcnt lgkmcnt(15)
    v_mfma_f32_32x32x16_bf16 v[128:143], v[204:207], v[108:111], v[128:143]
    ds_read_b64_tr_b16 v[184:185], v26 offset:4096
    ds_read_b64_tr_b16 v[186:187], v26 offset:6144
    v_mfma_f32_32x32x16_bf16 v[128:143], v[208:211], v[112:115], v[128:143]
    ds_read_b64_tr_b16 v[188:189], v27 offset:4096
    ds_read_b64_tr_b16 v[190:191], v27 offset:6144
    s_waitcnt lgkmcnt(15)
    v_mfma_f32_32x32x16_bf16 v[128:143], v[212:215], v[116:119], v[128:143]
    v_mfma_f32_32x32x16_bf16 v[128:143], v[216:219], v[120:123], v[128:143]
    v_mfma_f32_32x32x16_bf16 v[128:143], v[220:223], v[124:127], v[128:143]
    s_waitcnt vmcnt(8)
    s_barrier
    v_add_u32 v16, 32768, v9
    v_xor_b32 v17, 32, v16
    v_xor_b32 v18, 64, v16
    v_xor_b32 v19, 96, v16
    v_xor_b32 v20, 128, v16
    v_xor_b32 v21, 160, v16
    v_xor_b32 v22, 192, v16
    v_xor_b32 v23, 224, v16
    s_nop 2
    v_exp_f32 v128, v128
    v_exp_f32 v129, v129
    v_exp_f32 v130, v130
    v_exp_f32 v131, v131
    v_add_f32 v15, v128, v129
    v_exp_f32 v132, v132
    v_add_f32 v31, v130, v131
    v_exp_f32 v133, v133
    v_add_f32 v15, v15, v132
    v_exp_f32 v134, v134
    v_add_f32 v31, v31, v133
    v_exp_f32 v135, v135
    v_add_f32 v15, v15, v134
    v_exp_f32 v136, v136
    v_add_f32 v31, v31, v135
    v_exp_f32 v137, v137
    v_add_f32 v15, v15, v136
    v_exp_f32 v138, v138
    v_add_f32 v31, v31, v137
    v_exp_f32 v139, v139
    v_add_f32 v15, v15, v138
    v_exp_f32 v140, v140
    v_add_f32 v31, v31, v139
    v_exp_f32 v141, v141
    v_add_f32 v15, v15, v140
    v_exp_f32 v142, v142
    v_add_f32 v31, v31, v141
    v_exp_f32 v143, v143
    v_add_f32 v15, v15, v142
    v_add_f32 v15, v15, v31
    v_add_f32 v15, v15, v143
    v_cmp_lt_f32 vcc, s43, v15
    s_cbranch_vccnz SLOWS12
SLOWR12:
    ds_read_b128 v[192:195], v16
    ds_read_b128 v[196:199], v17
    ds_read_b128 v[200:203], v18
    ds_read_b128 v[204:207], v19
    ds_read_b128 v[208:211], v20
    ds_read_b128 v[212:215], v21
    ds_read_b128 v[216:219], v22
    ds_read_b128 v[220:223], v23
    v_add_f32 v13, v13, v15
    v_cvt_pk_bf16_f32 v128, v128, v129
    v_cvt_pk_bf16_f32 v129, v130, v131
    v_cvt_pk_bf16_f32 v130, v132, v133
    v_cvt_pk_bf16_f32 v131, v134, v135
    v_cvt_pk_bf16_f32 v132, v136, v137
    v_cvt_pk_bf16_f32 v133, v138, v139
    v_cvt_pk_bf16_f32 v134, v140, v141
    v_cvt_pk_bf16_f32 v135, v142, v143
    s_waitcnt lgkmcnt(8)
    s_barrier
    v_mfma_f32_32x32x16_bf16 v[32:47], v[160:163], v[128:131], v[32:47]
    s_add_u32 m0, s54, 98304
    s_mov_b32 s58, 122880
    buffer_load_dwordx4 v3, s[16:19], s58 offen nt lds
    v_mfma_f32_32x32x16_bf16 v[48:63], v[164:167], v[128:131], v[48:63]
    buffer_load_dwordx4 v4, s[16:19], s58 offen offset:1024 nt lds
    v_mfma_f32_32x32x16_bf16 v[64:79], v[168:171], v[128:131], v[64:79]
    s_add_u32 m0, s54, 106496
    s_nop 0
    buffer_load_dwordx4 v5, s[20:23], s58 offen nt lds
    v_mfma_f32_32x32x16_bf16 v[80:95], v[172:175], v[128:131], v[80:95]
    buffer_load_dwordx4 v5, s[20:23], s58 offen offset:1024 nt lds
    v_mfma_f32_32x32x16_bf16 v[32:47], v[176:179], v[132:135], v[32:47]
    s_add_u32 m0, s55, 0
    s_mov_b32 s58, 128
    buffer_load_dwordx4 v6, s[24:27], s58 offen lds
    v_add_u32 v24, 32768, v10
    v_xor_b32 v25, 64, v24
    v_xor_b32 v26, 128, v24
    v_xor_b32 v27, 192, v24
    v_mfma_f32_32x32x16_bf16 v[48:63], v[180:183], v[132:135], v[48:63]
    buffer_load_dwordx4 v28, s[24:27], s58 offen offset:1024 lds
    ds_read_b64_tr_b16 v[160:161], v24 offset:0
    ds_read_b64_tr_b16 v[162:163], v24 offset:2048
    v_mfma_f32_32x32x16_bf16 v[64:79], v[184:187], v[132:135], v[64:79]
    buffer_load_dwordx4 v29, s[24:27], s58 offen offset:2048 lds
    ds_read_b64_tr_b16 v[164:165], v25 offset:0
    ds_read_b64_tr_b16 v[166:167], v25 offset:2048
    v_mfma_f32_32x32x16_bf16 v[80:95], v[188:191], v[132:135], v[80:95]
    buffer_load_dwordx4 v30, s[24:27], s58 offen offset:3072 lds
    ds_read_b64_tr_b16 v[168:169], v26 offset:0
    ds_read_b64_tr_b16 v[170:171], v26 offset:2048
    s_waitcnt lgkmcnt(13)
    v_mfma_f32_32x32x16_bf16 v[128:143], v[192:195], v[96:99], v[144:159]
    ds_read_b64_tr_b16 v[172:173], v27 offset:0
    ds_read_b64_tr_b16 v[174:175], v27 offset:2048
    s_waitcnt lgkmcnt(14)
    v_mfma_f32_32x32x16_bf16 v[128:143], v[196:199], v[100:103], v[128:143]
    ds_read_b64_tr_b16 v[176:177], v24 offset:4096
    ds_read_b64_tr_b16 v[178:179], v24 offset:6144
    s_waitcnt lgkmcnt(15)
    v_mfma_f32_32x32x16_bf16 v[128:143], v[200:203], v[104:107], v[128:143]
    ds_read_b64_tr_b16 v[180:181], v25 offset:4096
    ds_read_b64_tr_b16 v[182:183], v25 offset:6144
    s_waitcnt lgkmcnt(15)
    v_mfma_f32_32x32x16_bf16 v[128:143], v[204:207], v[108:111], v[128:143]
    ds_read_b64_tr_b16 v[184:185], v26 offset:4096
    ds_read_b64_tr_b16 v[186:187], v26 offset:6144
    v_mfma_f32_32x32x16_bf16 v[128:143], v[208:211], v[112:115], v[128:143]
    ds_read_b64_tr_b16 v[188:189], v27 offset:4096
    ds_read_b64_tr_b16 v[190:191], v27 offset:6144
    s_waitcnt lgkmcnt(15)
    v_mfma_f32_32x32x16_bf16 v[128:143], v[212:215], v[116:119], v[128:143]
    v_mfma_f32_32x32x16_bf16 v[128:143], v[216:219], v[120:123], v[128:143]
    v_mfma_f32_32x32x16_bf16 v[128:143], v[220:223], v[124:127], v[128:143]
    s_waitcnt vmcnt(12)
    s_barrier
    v_add_u32 v16, 65536, v9
    v_xor_b32 v17, 32, v16
    v_xor_b32 v18, 64, v16
    v_xor_b32 v19, 96, v16
    v_xor_b32 v20, 128, v16
    v_xor_b32 v21, 160, v16
    v_xor_b32 v22, 192, v16
    v_xor_b32 v23, 224, v16
    s_nop 2
    v_exp_f32 v128, v128
    v_exp_f32 v129, v129
    v_exp_f32 v130, v130
    v_exp_f32 v131, v131
    v_add_f32 v15, v128, v129
    v_exp_f32 v132, v132
    v_add_f32 v31, v130, v131
    v_exp_f32 v133, v133
    v_add_f32 v15, v15, v132
    v_exp_f32 v134, v134
    v_add_f32 v31, v31, v133
    v_exp_f32 v135, v135
    v_add_f32 v15, v15, v134
    v_exp_f32 v136, v136
    v_add_f32 v31, v31, v135
    v_exp_f32 v137, v137
    v_add_f32 v15, v15, v136
    v_exp_f32 v138, v138
    v_add_f32 v31, v31, v137
    v_exp_f32 v139, v139
    v_add_f32 v15, v15, v138
    v_exp_f32 v140, v140
    v_add_f32 v31, v31, v139
    v_exp_f32 v141, v141
    v_add_f32 v15, v15, v140
    v_exp_f32 v142, v142
    v_add_f32 v31, v31, v141
    v_exp_f32 v143, v143
    v_add_f32 v15, v15, v142
    v_add_f32 v15, v15, v31
    v_add_f32 v15, v15, v143
    v_cmp_lt_f32 vcc, s43, v15
    s_cbranch_vccnz SLOWS13
SLOWR13:
    ds_read_b128 v[192:195], v16
    ds_read_b128 v[196:199], v17
    ds_read_b128 v[200:203], v18
    ds_read_b128 v[204:207], v19
    ds_read_b128 v[208:211], v20
    ds_read_b128 v[212:215], v21
    ds_read_b128 v[216:219], v22
    ds_read_b128 v[220:223], v23
    v_add_f32 v13, v13, v15
    v_cvt_pk_bf16_f32 v128, v128, v129
    v_cvt_pk_bf16_f32 v129, v130, v131
    v_cvt_pk_bf16_f32 v130, v132, v133
    v_cvt_pk_bf16_f32 v131, v134, v135
    v_cvt_pk_bf16_f32 v132, v136, v137
    v_cvt_pk_bf16_f32 v133, v138, v139
    v_cvt_pk_bf16_f32 v134, v140, v141
    v_cvt_pk_bf16_f32 v135, v142, v143
    s_waitcnt lgkmcnt(8)
    s_barrier
    v_mfma_f32_32x32x16_bf16 v[32:47], v[160:163], v[128:131], v[32:47]
    s_add_u32 m0, s55, 32768
    s_mov_b32 s58, 256
    buffer_load_dwordx4 v6, s[24:27], s58 offen lds
    v_mfma_f32_32x32x16_bf16 v[48:63], v[164:167], v[128:131], v[48:63]
    buffer_load_dwordx4 v28, s[24:27], s58 offen offset:1024 lds
    v_mfma_f32_32x32x16_bf16 v[64:79], v[168:171], v[128:131], v[64:79]
    buffer_load_dwordx4 v29, s[24:27], s58 offen offset:2048 lds
    v_mfma_f32_32x32x16_bf16 v[80:95], v[172:175], v[128:131], v[80:95]
    buffer_load_dwordx4 v30, s[24:27], s58 offen offset:3072 lds
    v_mfma_f32_32x32x16_bf16 v[32:47], v[176:179], v[132:135], v[32:47]
    v_add_u32 v24, 65536, v10
    v_xor_b32 v25, 64, v24
    v_xor_b32 v26, 128, v24
    v_xor_b32 v27, 192, v24
    v_mfma_f32_32x32x16_bf16 v[48:63], v[180:183], v[132:135], v[48:63]
    ds_read_b64_tr_b16 v[160:161], v24 offset:0
    ds_read_b64_tr_b16 v[162:163], v24 offset:2048
    v_mfma_f32_32x32x16_bf16 v[64:79], v[184:187], v[132:135], v[64:79]
    ds_read_b64_tr_b16 v[164:165], v25 offset:0
    ds_read_b64_tr_b16 v[166:167], v25 offset:2048
    v_mfma_f32_32x32x16_bf16 v[80:95], v[188:191], v[132:135], v[80:95]
    ds_read_b64_tr_b16 v[168:169], v26 offset:0
    ds_read_b64_tr_b16 v[170:171], v26 offset:2048
    s_waitcnt lgkmcnt(13)
    v_mfma_f32_32x32x16_bf16 v[128:143], v[192:195], v[96:99], v[144:159]
    ds_read_b64_tr_b16 v[172:173], v27 offset:0
    ds_read_b64_tr_b16 v[174:175], v27 offset:2048
    s_waitcnt lgkmcnt(14)
    v_mfma_f32_32x32x16_bf16 v[128:143], v[196:199], v[100:103], v[128:143]
    ds_read_b64_tr_b16 v[176:177], v24 offset:4096
    ds_read_b64_tr_b16 v[178:179], v24 offset:6144
    s_waitcnt lgkmcnt(15)
    v_mfma_f32_32x32x16_bf16 v[128:143], v[200:203], v[104:107], v[128:143]
    ds_read_b64_tr_b16 v[180:181], v25 offset:4096
    ds_read_b64_tr_b16 v[182:183], v25 offset:6144
    s_waitcnt lgkmcnt(15)
    v_mfma_f32_32x32x16_bf16 v[128:143], v[204:207], v[108:111], v[128:143]
    ds_read_b64_tr_b16 v[184:185], v26 offset:4096
    ds_read_b64_tr_b16 v[186:187], v26 offset:6144
    v_mfma_f32_32x32x16_bf16 v[128:143], v[208:211], v[112:115], v[128:143]
    ds_read_b64_tr_b16 v[188:189], v27 offset:4096
    ds_read_b64_tr_b16 v[190:191], v27 offset:6144
    s_waitcnt lgkmcnt(15)
    v_mfma_f32_32x32x16_bf16 v[128:143], v[212:215], v[116:119], v[128:143]
    v_mfma_f32_32x32x16_bf16 v[128:143], v[216:219], v[120:123], v[128:143]
    v_mfma_f32_32x32x16_bf16 v[128:143], v[220:223], v[124:127], v[128:143]
    s_waitcnt vmcnt(8)
    s_barrier
    v_add_u32 v16, 98304, v9
    v_xor_b32 v17, 32, v16
    v_xor_b32 v18, 64, v16
    v_xor_b32 v19, 96, v16
    v_xor_b32 v20, 128, v16
    v_xor_b32 v21, 160, v16
    v_xor_b32 v22, 192, v16
    v_xor_b32 v23, 224, v16
    s_nop 2
    v_exp_f32 v128, v128
    v_exp_f32 v129, v129
    v_exp_f32 v130, v130
    v_exp_f32 v131, v131
    v_add_f32 v15, v128, v129
    v_exp_f32 v132, v132
    v_add_f32 v31, v130, v131
    v_exp_f32 v133, v133
    v_add_f32 v15, v15, v132
    v_exp_f32 v134, v134
    v_add_f32 v31, v31, v133
    v_exp_f32 v135, v135
    v_add_f32 v15, v15, v134
    v_exp_f32 v136, v136
    v_add_f32 v31, v31, v135
    v_exp_f32 v137, v137
    v_add_f32 v15, v15, v136
    v_exp_f32 v138, v138
    v_add_f32 v31, v31, v137
    v_exp_f32 v139, v139
    v_add_f32 v15, v15, v138
    v_exp_f32 v140, v140
    v_add_f32 v31, v31, v139
    v_exp_f32 v141, v141
    v_add_f32 v15, v15, v140
    v_exp_f32 v142, v142
    v_add_f32 v31, v31, v141
    v_exp_f32 v143, v143
    v_add_f32 v15, v15, v142
    v_add_f32 v15, v15, v31
    v_add_f32 v15, v15, v143
    v_cmp_lt_f32 vcc, s43, v15
    s_cbranch_vccnz SLOWS14
SLOWR14:
    ds_read_b128 v[192:195], v16
    ds_read_b128 v[196:199], v17
    ds_read_b128 v[200:203], v18
    ds_read_b128 v[204:207], v19
    ds_read_b128 v[208:211], v20
    ds_read_b128 v[212:215], v21
    ds_read_b128 v[216:219], v22
    ds_read_b128 v[220:223], v23
    v_add_f32 v13, v13, v15
    v_cvt_pk_bf16_f32 v128, v128, v129
    v_cvt_pk_bf16_f32 v129, v130, v131
    v_cvt_pk_bf16_f32 v130, v132, v133
    v_cvt_pk_bf16_f32 v131, v134, v135
    v_cvt_pk_bf16_f32 v132, v136, v137
    v_cvt_pk_bf16_f32 v133, v138, v139
    v_cvt_pk_bf16_f32 v134, v140, v141
    v_cvt_pk_bf16_f32 v135, v142, v143
    s_waitcnt lgkmcnt(8)
    s_barrier
    v_mfma_f32_32x32x16_bf16 v[32:47], v[160:163], v[128:131], v[32:47]
    v_mfma_f32_32x32x16_bf16 v[48:63], v[164:167], v[128:131], v[48:63]
    v_mfma_f32_32x32x16_bf16 v[64:79], v[168:171], v[128:131], v[64:79]
    v_mfma_f32_32x32x16_bf16 v[80:95], v[172:175], v[128:131], v[80:95]
    v_mfma_f32_32x32x16_bf16 v[32:47], v[176:179], v[132:135], v[32:47]
    v_add_u32 v24, 98304, v10
    v_xor_b32 v25, 64, v24
    v_xor_b32 v26, 128, v24
    v_xor_b32 v27, 192, v24
    v_mfma_f32_32x32x16_bf16 v[48:63], v[180:183], v[132:135], v[48:63]
    ds_read_b64_tr_b16 v[160:161], v24 offset:0
    ds_read_b64_tr_b16 v[162:163], v24 offset:2048
    v_mfma_f32_32x32x16_bf16 v[64:79], v[184:187], v[132:135], v[64:79]
    ds_read_b64_tr_b16 v[164:165], v25 offset:0
    ds_read_b64_tr_b16 v[166:167], v25 offset:2048
    v_mfma_f32_32x32x16_bf16 v[80:95], v[188:191], v[132:135], v[80:95]
    ds_read_b64_tr_b16 v[168:169], v26 offset:0
    ds_read_b64_tr_b16 v[170:171], v26 offset:2048
    s_waitcnt lgkmcnt(13)
    v_mfma_f32_32x32x16_bf16 v[128:143], v[192:195], v[96:99], v[144:159]
    ds_read_b64_tr_b16 v[172:173], v27 offset:0
    ds_read_b64_tr_b16 v[174:175], v27 offset:2048
    s_waitcnt lgkmcnt(14)
    v_mfma_f32_32x32x16_bf16 v[128:143], v[196:199], v[100:103], v[128:143]
    ds_read_b64_tr_b16 v[176:177], v24 offset:4096
    ds_read_b64_tr_b16 v[178:179], v24 offset:6144
    s_waitcnt lgkmcnt(15)
    v_mfma_f32_32x32x16_bf16 v[128:143], v[200:203], v[104:107], v[128:143]
    ds_read_b64_tr_b16 v[180:181], v25 offset:4096
    ds_read_b64_tr_b16 v[182:183], v25 offset:6144
    s_waitcnt lgkmcnt(15)
    v_mfma_f32_32x32x16_bf16 v[128:143], v[204:207], v[108:111], v[128:143]
    ds_read_b64_tr_b16 v[184:185], v26 offset:4096
    ds_read_b64_tr_b16 v[186:187], v26 offset:6144
    v_mfma_f32_32x32x16_bf16 v[128:143], v[208:211], v[112:115], v[128:143]
    ds_read_b64_tr_b16 v[188:189], v27 offset:4096
    ds_read_b64_tr_b16 v[190:191], v27 offset:6144
    s_waitcnt lgkmcnt(15)
    v_mfma_f32_32x32x16_bf16 v[128:143], v[212:215], v[116:119], v[128:143]
    v_mfma_f32_32x32x16_bf16 v[128:143], v[216:219], v[120:123], v[128:143]
    v_mfma_f32_32x32x16_bf16 v[128:143], v[220:223], v[124:127], v[128:143]
    s_barrier
    s_nop 10
    v_exp_f32 v128, v128
    v_exp_f32 v129, v129
    v_exp_f32 v130, v130
    v_exp_f32 v131, v131
    v_add_f32 v15, v128, v129
    v_exp_f32 v132, v132
    v_add_f32 v31, v130, v131
    v_exp_f32 v133, v133
    v_add_f32 v15, v15, v132
    v_exp_f32 v134, v134
    v_add_f32 v31, v31, v133
    v_exp_f32 v135, v135
    v_add_f32 v15, v15, v134
    v_exp_f32 v136, v136
    v_add_f32 v31, v31, v135
    v_exp_f32 v137, v137
    v_add_f32 v15, v15, v136
    v_exp_f32 v138, v138
    v_add_f32 v31, v31, v137
    v_exp_f32 v139, v139
    v_add_f32 v15, v15, v138
    v_exp_f32 v140, v140
    v_add_f32 v31, v31, v139
    v_exp_f32 v141, v141
    v_add_f32 v15, v15, v140
    v_exp_f32 v142, v142
    v_add_f32 v31, v31, v141
    v_exp_f32 v143, v143
    v_add_f32 v15, v15, v142
    v_add_f32 v15, v15, v31
    v_add_f32 v15, v15, v143
    v_cmp_lt_f32 vcc, s43, v15
    s_cbranch_vccnz SLOWS15
SLOWR15:
    v_add_f32 v13, v13, v15
    v_cvt_pk_bf16_f32 v128, v128, v129
    v_cvt_pk_bf16_f32 v129, v130, v131
    v_cvt_pk_bf16_f32 v130, v132, v133
    v_cvt_pk_bf16_f32 v131, v134, v135
    v_cvt_pk_bf16_f32 v132, v136, v137
    v_cvt_pk_bf16_f32 v133, v138, v139
    v_cvt_pk_bf16_f32 v134, v140, v141
    v_cvt_pk_bf16_f32 v135, v142, v143
    s_waitcnt lgkmcnt(0)
    s_barrier
    v_mfma_f32_32x32x16_bf16 v[32:47], v[160:163], v[128:131], v[32:47]
    v_mov_b32 v15, v13
    v_mfma_f32_32x32x16_bf16 v[48:63], v[164:167], v[128:131], v[48:63]
    s_nop 0
    v_mfma_f32_32x32x16_bf16 v[64:79], v[168:171], v[128:131], v[64:79]
    v_permlane32_swap_b32 v13, v15
    v_mfma_f32_32x32x16_bf16 v[80:95], v[172:175], v[128:131], v[80:95]
    s_nop 0
    v_mfma_f32_32x32x16_bf16 v[32:47], v[176:179], v[132:135], v[32:47]
    v_add_f32 v13, v13, v15
    v_mfma_f32_32x32x16_bf16 v[48:63], v[180:183], v[132:135], v[48:63]
    v_rcp_f32 v14, v13
    v_mfma_f32_32x32x16_bf16 v[64:79], v[184:187], v[132:135], v[64:79]
    v_mfma_f32_32x32x16_bf16 v[80:95], v[188:191], v[132:135], v[80:95]
    s_lshr_b32 s3, s42, 1
    s_add_u32 s3, s3, 2
    s_lshl_b32 s3, s3, 15
    s_lshl_b32 s4, s41, 14
    s_add_u32 s3, s3, s4
    s_and_b32 s4, s42, 1
    s_lshl_b32 s4, s4, 13
    s_add_u32 s3, s3, s4
    v_add_u32 v15, s3, v12
    v_xor_b32 v31, 16384, v15
    s_nop 0
    v_pk_mul_f32 v[32:33], v[32:33], v[14:15] op_sel_hi:[1,0]
    v_pk_mul_f32 v[34:35], v[34:35], v[14:15] op_sel_hi:[1,0]
    v_pk_mul_f32 v[36:37], v[36:37], v[14:15] op_sel_hi:[1,0]
    v_pk_mul_f32 v[38:39], v[38:39], v[14:15] op_sel_hi:[1,0]
    v_cvt_pk_bf16_f32 v96, v32, v33
    v_cvt_pk_bf16_f32 v97, v34, v35
    v_cvt_pk_bf16_f32 v98, v36, v37
    v_cvt_pk_bf16_f32 v99, v38, v39
    ds_write_b128 v15, v[96:99] offset:0
    v_pk_mul_f32 v[40:41], v[40:41], v[14:15] op_sel_hi:[1,0]
    v_pk_mul_f32 v[42:43], v[42:43], v[14:15] op_sel_hi:[1,0]
    v_pk_mul_f32 v[44:45], v[44:45], v[14:15] op_sel_hi:[1,0]
    v_pk_mul_f32 v[46:47], v[46:47], v[14:15] op_sel_hi:[1,0]
    v_cvt_pk_bf16_f32 v100, v40, v41
    v_cvt_pk_bf16_f32 v101, v42, v43
    v_cvt_pk_bf16_f32 v102, v44, v45
    v_cvt_pk_bf16_f32 v103, v46, v47
    ds_write_b128 v15, v[100:103] offset:1024
    v_pk_mul_f32 v[48:49], v[48:49], v[14:15] op_sel_hi:[1,0]
    v_pk_mul_f32 v[50:51], v[50:51], v[14:15] op_sel_hi:[1,0]
    v_pk_mul_f32 v[52:53], v[52:53], v[14:15] op_sel_hi:[1,0]
    v_pk_mul_f32 v[54:55], v[54:55], v[14:15] op_sel_hi:[1,0]
    v_cvt_pk_bf16_f32 v104, v48, v49
    v_cvt_pk_bf16_f32 v105, v50, v51
    v_cvt_pk_bf16_f32 v106, v52, v53
    v_cvt_pk_bf16_f32 v107, v54, v55
    ds_write_b128 v15, v[104:107] offset:2048
    v_pk_mul_f32 v[56:57], v[56:57], v[14:15] op_sel_hi:[1,0]
    v_pk_mul_f32 v[58:59], v[58:59], v[14:15] op_sel_hi:[1,0]
    v_pk_mul_f32 v[60:61], v[60:61], v[14:15] op_sel_hi:[1,0]
    v_pk_mul_f32 v[62:63], v[62:63], v[14:15] op_sel_hi:[1,0]
    v_cvt_pk_bf16_f32 v108, v56, v57
    v_cvt_pk_bf16_f32 v109, v58, v59
    v_cvt_pk_bf16_f32 v110, v60, v61
    v_cvt_pk_bf16_f32 v111, v62, v63
    ds_write_b128 v15, v[108:111] offset:3072
    v_pk_mul_f32 v[64:65], v[64:65], v[14:15] op_sel_hi:[1,0]
    v_pk_mul_f32 v[66:67], v[66:67], v[14:15] op_sel_hi:[1,0]
    v_pk_mul_f32 v[68:69], v[68:69], v[14:15] op_sel_hi:[1,0]
    v_pk_mul_f32 v[70:71], v[70:71], v[14:15] op_sel_hi:[1,0]
    v_cvt_pk_bf16_f32 v112, v64, v65
    v_cvt_pk_bf16_f32 v113, v66, v67
    v_cvt_pk_bf16_f32 v114, v68, v69
    v_cvt_pk_bf16_f32 v115, v70, v71
    ds_write_b128 v15, v[112:115] offset:4096
    v_pk_mul_f32 v[72:73], v[72:73], v[14:15] op_sel_hi:[1,0]
    v_pk_mul_f32 v[74:75], v[74:75], v[14:15] op_sel_hi:[1,0]
    v_pk_mul_f32 v[76:77], v[76:77], v[14:15] op_sel_hi:[1,0]
    v_pk_mul_f32 v[78:79], v[78:79], v[14:15] op_sel_hi:[1,0]
    v_cvt_pk_bf16_f32 v116, v72, v73
    v_cvt_pk_bf16_f32 v117, v74, v75
    v_cvt_pk_bf16_f32 v118, v76, v77
    v_cvt_pk_bf16_f32 v119, v78, v79
    ds_write_b128 v15, v[116:119] offset:5120
    v_pk_mul_f32 v[80:81], v[80:81], v[14:15] op_sel_hi:[1,0]
    v_pk_mul_f32 v[82:83], v[82:83], v[14:15] op_sel_hi:[1,0]
    v_pk_mul_f32 v[84:85], v[84:85], v[14:15] op_sel_hi:[1,0]
    v_pk_mul_f32 v[86:87], v[86:87], v[14:15] op_sel_hi:[1,0]
    v_cvt_pk_bf16_f32 v120, v80, v81
    v_cvt_pk_bf16_f32 v121, v82, v83
    v_cvt_pk_bf16_f32 v122, v84, v85
    v_cvt_pk_bf16_f32 v123, v86, v87
    ds_write_b128 v15, v[120:123] offset:6144
    v_pk_mul_f32 v[88:89], v[88:89], v[14:15] op_sel_hi:[1,0]
    v_pk_mul_f32 v[90:91], v[90:91], v[14:15] op_sel_hi:[1,0]
    v_pk_mul_f32 v[92:93], v[92:93], v[14:15] op_sel_hi:[1,0]
    v_pk_mul_f32 v[94:95], v[94:95], v[14:15] op_sel_hi:[1,0]
    v_cvt_pk_bf16_f32 v124, v88, v89
    v_cvt_pk_bf16_f32 v125, v90, v91
    v_cvt_pk_bf16_f32 v126, v92, v93
    v_cvt_pk_bf16_f32 v127, v94, v95
    ds_write_b128 v15, v[124:127] offset:7168
    s_waitcnt lgkmcnt(0)
    s_cmp_eq_u32 s41, 0
    s_cbranch_scc0 XSKIP
    s_barrier
XSKIP:
    s_barrier
    v_add_u32 v16, 131072, v11
    v_xor_b32 v17, 16384, v16
    ds_read_b64_tr_b16 v[192:193], v16 offset:0
    ds_read_b64_tr_b16 v[194:195], v16 offset:1024
    ds_read_b64_tr_b16 v[196:197], v16 offset:2048
    ds_read_b64_tr_b16 v[198:199], v16 offset:3072
    ds_read_b64_tr_b16 v[200:201], v16 offset:4096
    s_waitcnt lgkmcnt(3)
    v_mfma_f32_32x32x16_bf16 v[160:175], v[192:195], v[96:99], 0
    ds_read_b64_tr_b16 v[202:203], v16 offset:5120
    ds_read_b64_tr_b16 v[204:205], v16 offset:6144
    ds_read_b64_tr_b16 v[206:207], v16 offset:7168
    ds_read_b64_tr_b16 v[208:209], v16 offset:8192
    ds_read_b64_tr_b16 v[210:211], v16 offset:9216
    ds_read_b64_tr_b16 v[212:213], v16 offset:10240
    ds_read_b64_tr_b16 v[214:215], v16 offset:11264
    ds_read_b64_tr_b16 v[216:217], v16 offset:12288
    ds_read_b64_tr_b16 v[218:219], v16 offset:13312
    ds_read_b64_tr_b16 v[220:221], v16 offset:14336
    ds_read_b64_tr_b16 v[222:223], v16 offset:15360
    ds_read_b64_tr_b16 v[224:225], v17 offset:0
    ds_read_b64_tr_b16 v[226:227], v17 offset:1024
    ds_read_b64_tr_b16 v[228:229], v17 offset:2048
    ds_read_b64_tr_b16 v[230:231], v17 offset:3072
    ds_read_b64_tr_b16 v[232:233], v17 offset:4096
    ds_read_b64_tr_b16 v[234:235], v17 offset:5120
    ds_read_b64_tr_b16 v[236:237], v17 offset:6144
    ds_read_b64_tr_b16 v[238:239], v17 offset:7168
    ds_read_b64_tr_b16 v[192:193], v17 offset:8192
    ds_read_b64_tr_b16 v[194:195], v17 offset:9216
    ds_read_b128 v[128:131], v31 offset:0
    ds_read_b128 v[132:135], v31 offset:1024
    s_waitcnt lgkmcnt(15)
    v_mfma_f32_32x32x16_bf16 v[160:175], v[196:199], v[100:103], v[160:175]
    ds_read_b64_tr_b16 v[196:197], v17 offset:10240
    ds_read_b64_tr_b16 v[198:199], v17 offset:11264
    ds_read_b128 v[136:139], v31 offset:2048
    ds_read_b128 v[140:143], v31 offset:3072
    v_mfma_f32_32x32x16_bf16 v[160:175], v[200:203], v[104:107], v[160:175]
    ds_read_b64_tr_b16 v[200:201], v17 offset:12288
    ds_read_b64_tr_b16 v[202:203], v17 offset:13312
    ds_read_b128 v[144:147], v31 offset:4096
    ds_read_b128 v[148:151], v31 offset:5120
    v_mfma_f32_32x32x16_bf16 v[160:175], v[204:207], v[108:111], v[160:175]
    ds_read_b64_tr_b16 v[204:205], v17 offset:14336
    ds_read_b64_tr_b16 v[206:207], v17 offset:15360
    ds_read_b128 v[152:155], v31 offset:6144
    ds_read_b128 v[156:159], v31 offset:7168
    v_mfma_f32_32x32x16_bf16 v[160:175], v[208:211], v[112:115], v[160:175]
    buffer_load_dwordx2 v[20:21], off, s[48:51], 0 sc1
    v_mfma_f32_32x32x16_bf16 v[160:175], v[212:215], v[116:119], v[160:175]
    s_lshl_b32 s3, s40, 11
    v_add_u32 v18, s3, v12
    s_cmp_eq_u32 s42, 3
    s_cselect_b32 s4, 256, 0
    v_and_b32 v27, s4, v12
    v_lshlrev_b32 v27, 22, v27
    v_or_b32 v18, v18, v27
    s_lshl_b32 s3, s40, 7
    s_lshl_b32 s4, s61, 3
    s_add_u32 s3, s3, s4
    v_min_u32 v27, 1, v12
    v_lshlrev_b32 v27, 30, v27
    v_add_u32 v19, s3, v27
    s_waitcnt lgkmcnt(15)
    v_mfma_f32_32x32x16_bf16 v[160:175], v[216:219], v[120:123], v[160:175]
    v_mfma_f32_32x32x16_bf16 v[160:175], v[220:223], v[124:127], v[160:175]
    s_waitcnt vmcnt(5) lgkmcnt(0)
    s_barrier
    v_add_u32 v16, 0, v11
    v_xor_b32 v17, 16384, v16
    ds_read_b64_tr_b16 v[208:209], v16 offset:0
    ds_read_b64_tr_b16 v[210:211], v16 offset:1024
    ds_read_b64_tr_b16 v[212:213], v16 offset:2048
    v_mfma_f32_32x32x16_bf16 v[160:175], v[224:227], v[128:131], v[160:175]
    ds_read_b64_tr_b16 v[214:215], v16 offset:3072
    ds_read_b64_tr_b16 v[216:217], v16 offset:4096
    ds_read_b64_tr_b16 v[218:219], v16 offset:5120
    s_add_u32 m0, s55, 65536
    s_mov_b32 s58, 384
    buffer_load_dwordx4 v6, s[24:27], s58 offen lds
    v_mfma_f32_32x32x16_bf16 v[160:175], v[228:231], v[132:135], v[160:175]
    ds_read_b64_tr_b16 v[220:221], v16 offset:6144
    ds_read_b64_tr_b16 v[222:223], v16 offset:7168
    ds_read_b64_tr_b16 v[224:225], v16 offset:8192
    buffer_load_dwordx4 v28, s[24:27], s58 offen offset:1024 lds
    v_mfma_f32_32x32x16_bf16 v[160:175], v[232:235], v[136:139], v[160:175]
    ds_read_b64_tr_b16 v[226:227], v16 offset:9216
    ds_read_b64_tr_b16 v[228:229], v16 offset:10240
    ds_read_b64_tr_b16 v[230:231], v16 offset:11264
    buffer_load_dwordx4 v29, s[24:27], s58 offen offset:2048 lds
    v_mfma_f32_32x32x16_bf16 v[160:175], v[236:239], v[140:143], v[160:175]
    ds_read_b64_tr_b16 v[232:233], v16 offset:12288
    ds_read_b64_tr_b16 v[234:235], v16 offset:13312
    ds_read_b64_tr_b16 v[236:237], v16 offset:14336
    buffer_load_dwordx4 v30, s[24:27], s58 offen offset:3072 lds
    v_mfma_f32_32x32x16_bf16 v[160:175], v[192:195], v[144:147], v[160:175]
    ds_read_b64_tr_b16 v[238:239], v16 offset:15360
    ds_read_b64_tr_b16 v[192:193], v17 offset:0
    ds_read_b64_tr_b16 v[194:195], v17 offset:1024
    v_mfma_f32_32x32x16_bf16 v[160:175], v[196:199], v[148:151], v[160:175]
    ds_read_b64_tr_b16 v[196:197], v17 offset:2048
    ds_read_b64_tr_b16 v[198:199], v17 offset:3072
    v_mfma_f32_32x32x16_bf16 v[160:175], v[200:203], v[152:155], v[160:175]
    ds_read_b64_tr_b16 v[200:201], v17 offset:4096
    ds_read_b64_tr_b16 v[202:203], v17 offset:5120
    v_mfma_f32_32x32x16_bf16 v[160:175], v[204:207], v[156:159], v[160:175]
    ds_read_b64_tr_b16 v[204:205], v17 offset:6144
    ds_read_b64_tr_b16 v[206:207], v17 offset:7168
    s_waitcnt lgkmcnt(15)
    v_mfma_f32_32x32x16_bf16 v[176:191], v[208:211], v[96:99], 0
    ds_read_b64_tr_b16 v[208:209], v17 offset:8192
    ds_read_b64_tr_b16 v[210:211], v17 offset:9216
    v_mfma_f32_32x32x16_bf16 v[176:191], v[212:215], v[100:103], v[176:191]
    ds_read_b64_tr_b16 v[212:213], v17 offset:10240
    ds_read_b64_tr_b16 v[214:215], v17 offset:11264
    v_mfma_f32_32x32x16_bf16 v[176:191], v[216:219], v[104:107], v[176:191]
    ds_read_b64_tr_b16 v[216:217], v17 offset:12288
    ds_read_b64_tr_b16 v[218:219], v17 offset:13312
    v_mfma_f32_32x32x16_bf16 v[176:191], v[220:223], v[108:111], v[176:191]
    ds_read_b64_tr_b16 v[220:221], v17 offset:14336
    ds_read_b64_tr_b16 v[222:223], v17 offset:15360
    v_cvt_pk_bf16_f32 v240, v160, v161
    v_cvt_pk_bf16_f32 v241, v162, v163
    v_cvt_pk_bf16_f32 v242, v164, v165
    v_cvt_pk_bf16_f32 v243, v166, v167
    s_waitcnt lgkmcnt(15)
    v_mfma_f32_32x32x16_bf16 v[176:191], v[224:227], v[112:115], v[176:191]
    v_cvt_pk_bf16_f32 v244, v168, v169
    v_cvt_pk_bf16_f32 v245, v170, v171
    v_cvt_pk_bf16_f32 v246, v172, v173
    v_cvt_pk_bf16_f32 v247, v174, v175
    v_mfma_f32_32x32x16_bf16 v[176:191], v[228:231], v[116:119], v[176:191]
    s_mov_b32 s59, 0
    buffer_store_dwordx4 v[240:243], v18, s[28:31], s59 offen sc1
    buffer_store_dwordx4 v[244:247], v18, s[28:31], s59 offen offset:1024 sc1
    v_mfma_f32_32x32x16_bf16 v[176:191], v[232:235], v[120:123], v[176:191]
    v_mfma_f32_32x32x16_bf16 v[176:191], v[236:239], v[124:127], v[176:191]
    s_waitcnt vmcnt(7) lgkmcnt(0)
    s_barrier
    v_add_u32 v16, 32768, v11
    v_xor_b32 v17, 16384, v16
    ds_read_b64_tr_b16 v[224:225], v16 offset:0
    ds_read_b64_tr_b16 v[226:227], v16 offset:1024
    ds_read_b64_tr_b16 v[228:229], v16 offset:2048
    v_mfma_f32_32x32x16_bf16 v[176:191], v[192:195], v[128:131], v[176:191]
    ds_read_b64_tr_b16 v[230:231], v16 offset:3072
    ds_read_b64_tr_b16 v[232:233], v16 offset:4096
    ds_read_b64_tr_b16 v[234:235], v16 offset:5120
    s_add_u32 m0, s55, 98304
    s_mov_b32 s58, 512
    buffer_load_dwordx4 v6, s[24:27], s58 offen lds
    v_mfma_f32_32x32x16_bf16 v[176:191], v[196:199], v[132:135], v[176:191]
    ds_read_b64_tr_b16 v[236:237], v16 offset:6144
    ds_read_b64_tr_b16 v[238:239], v16 offset:7168
    ds_read_b64_tr_b16 v[192:193], v16 offset:8192
    buffer_load_dwordx4 v28, s[24:27], s58 offen offset:1024 lds
    v_mfma_f32_32x32x16_bf16 v[176:191], v[200:203], v[136:139], v[176:191]
    ds_read_b64_tr_b16 v[194:195], v16 offset:9216
    ds_read_b64_tr_b16 v[196:197], v16 offset:10240
    ds_read_b64_tr_b16 v[198:199], v16 offset:11264
    buffer_load_dwordx4 v29, s[24:27], s58 offen offset:2048 lds
    v_mfma_f32_32x32x16_bf16 v[176:191], v[204:207], v[140:143], v[176:191]
    ds_read_b64_tr_b16 v[200:201], v16 offset:12288
    ds_read_b64_tr_b16 v[202:203], v16 offset:13312
    ds_read_b64_tr_b16 v[204:205], v16 offset:14336
    buffer_load_dwordx4 v30, s[24:27], s58 offen offset:3072 lds
    v_mfma_f32_32x32x16_bf16 v[176:191], v[208:211], v[144:147], v[176:191]
    ds_read_b64_tr_b16 v[206:207], v16 offset:15360
    ds_read_b64_tr_b16 v[208:209], v17 offset:0
    ds_read_b64_tr_b16 v[210:211], v17 offset:1024
    v_mfma_f32_32x32x16_bf16 v[176:191], v[212:215], v[148:151], v[176:191]
    ds_read_b64_tr_b16 v[212:213], v17 offset:2048
    ds_read_b64_tr_b16 v[214:215], v17 offset:3072
    v_mfma_f32_32x32x16_bf16 v[176:191], v[216:219], v[152:155], v[176:191]
    ds_read_b64_tr_b16 v[216:217], v17 offset:4096
    ds_read_b64_tr_b16 v[218:219], v17 offset:5120
    v_mfma_f32_32x32x16_bf16 v[176:191], v[220:223], v[156:159], v[176:191]
    ds_read_b64_tr_b16 v[220:221], v17 offset:6144
    ds_read_b64_tr_b16 v[222:223], v17 offset:7168
    s_waitcnt lgkmcnt(15)
    v_mfma_f32_32x32x16_bf16 v[160:175], v[224:227], v[96:99], 0
    ds_read_b64_tr_b16 v[224:225], v17 offset:8192
    ds_read_b64_tr_b16 v[226:227], v17 offset:9216
    v_mfma_f32_32x32x16_bf16 v[160:175], v[228:231], v[100:103], v[160:175]
    ds_read_b64_tr_b16 v[228:229], v17 offset:10240
    ds_read_b64_tr_b16 v[230:231], v17 offset:11264
    v_mfma_f32_32x32x16_bf16 v[160:175], v[232:235], v[104:107], v[160:175]
    ds_read_b64_tr_b16 v[232:233], v17 offset:12288
    ds_read_b64_tr_b16 v[234:235], v17 offset:13312
    v_mfma_f32_32x32x16_bf16 v[160:175], v[236:239], v[108:111], v[160:175]
    ds_read_b64_tr_b16 v[236:237], v17 offset:14336
    ds_read_b64_tr_b16 v[238:239], v17 offset:15360
    v_cvt_pk_bf16_f32 v240, v176, v177
    v_cvt_pk_bf16_f32 v241, v178, v179
    v_cvt_pk_bf16_f32 v242, v180, v181
    v_cvt_pk_bf16_f32 v243, v182, v183
    s_waitcnt lgkmcnt(15)
    v_mfma_f32_32x32x16_bf16 v[160:175], v[192:195], v[112:115], v[160:175]
    v_cvt_pk_bf16_f32 v244, v184, v185
    v_cvt_pk_bf16_f32 v245, v186, v187
    v_cvt_pk_bf16_f32 v246, v188, v189
    v_cvt_pk_bf16_f32 v247, v190, v191
    v_mfma_f32_32x32x16_bf16 v[160:175], v[196:199], v[116:119], v[160:175]
    s_mov_b32 s59, 16384
    buffer_store_dwordx4 v[240:243], v18, s[28:31], s59 offen sc1
    buffer_store_dwordx4 v[244:247], v18, s[28:31], s59 offen offset:1024 sc1
    v_mfma_f32_32x32x16_bf16 v[160:175], v[200:203], v[120:123], v[160:175]
    v_mfma_f32_32x32x16_bf16 v[160:175], v[204:207], v[124:127], v[160:175]
    s_waitcnt vmcnt(6)
    s_mov_b32 s59, 0
    buffer_store_dwordx2 v[20:21], v19, s[44:47], s59 offen sc1
    s_waitcnt lgkmcnt(0)
    s_barrier
    v_add_u32 v16, 65536, v11
    v_xor_b32 v17, 16384, v16
    ds_read_b64_tr_b16 v[192:193], v16 offset:0
    ds_read_b64_tr_b16 v[194:195], v16 offset:1024
    ds_read_b64_tr_b16 v[196:197], v16 offset:2048
    v_mfma_f32_32x32x16_bf16 v[160:175], v[208:211], v[128:131], v[160:175]
    ds_read_b64_tr_b16 v[198:199], v16 offset:3072
    ds_read_b64_tr_b16 v[200:201], v16 offset:4096
    ds_read_b64_tr_b16 v[202:203], v16 offset:5120
    s_add_u32 m0, s55, 131072
    s_mov_b32 s58, 640
    buffer_load_dwordx4 v6, s[24:27], s58 offen lds
    v_mfma_f32_32x32x16_bf16 v[160:175], v[212:215], v[132:135], v[160:175]
    ds_read_b64_tr_b16 v[204:205], v16 offset:6144
    ds_read_b64_tr_b16 v[206:207], v16 offset:7168
    ds_read_b64_tr_b16 v[208:209], v16 offset:8192
    buffer_load_dwordx4 v28, s[24:27], s58 offen offset:1024 lds
    v_mfma_f32_32x32x16_bf16 v[160:175], v[216:219], v[136:139], v[160:175]
    ds_read_b64_tr_b16 v[210:211], v16 offset:9216
    ds_read_b64_tr_b16 v[212:213], v16 offset:10240
    ds_read_b64_tr_b16 v[214:215], v16 offset:11264
    buffer_load_dwordx4 v29, s[24:27], s58 offen offset:2048 lds
    v_mfma_f32_32x32x16_bf16 v[160:175], v[220:223], v[140:143], v[160:175]
    ds_read_b64_tr_b16 v[216:217], v16 offset:12288
    ds_read_b64_tr_b16 v[218:219], v16 offset:13312
    ds_read_b64_tr_b16 v[220:221], v16 offset:14336
    buffer_load_dwordx4 v30, s[24:27], s58 offen offset:3072 lds
    v_mfma_f32_32x32x16_bf16 v[160:175], v[224:227], v[144:147], v[160:175]
    ds_read_b64_tr_b16 v[222:223], v16 offset:15360
    ds_read_b64_tr_b16 v[224:225], v17 offset:0
    ds_read_b64_tr_b16 v[226:227], v17 offset:1024
    v_mfma_f32_32x32x16_bf16 v[160:175], v[228:231], v[148:151], v[160:175]
    ds_read_b64_tr_b16 v[228:229], v17 offset:2048
    ds_read_b64_tr_b16 v[230:231], v17 offset:3072
    v_mfma_f32_32x32x16_bf16 v[160:175], v[232:235], v[152:155], v[160:175]
    ds_read_b64_tr_b16 v[232:233], v17 offset:4096
    ds_read_b64_tr_b16 v[234:235], v17 offset:5120
    v_mfma_f32_32x32x16_bf16 v[160:175], v[236:239], v[156:159], v[160:175]
    ds_read_b64_tr_b16 v[236:237], v17 offset:6144
    ds_read_b64_tr_b16 v[238:239], v17 offset:7168
    s_waitcnt lgkmcnt(15)
    v_mfma_f32_32x32x16_bf16 v[176:191], v[192:195], v[96:99], 0
    ds_read_b64_tr_b16 v[192:193], v17 offset:8192
    ds_read_b64_tr_b16 v[194:195], v17 offset:9216
    v_mfma_f32_32x32x16_bf16 v[176:191], v[196:199], v[100:103], v[176:191]
    ds_read_b64_tr_b16 v[196:197], v17 offset:10240
    ds_read_b64_tr_b16 v[198:199], v17 offset:11264
    v_mfma_f32_32x32x16_bf16 v[176:191], v[200:203], v[104:107], v[176:191]
    ds_read_b64_tr_b16 v[200:201], v17 offset:12288
    ds_read_b64_tr_b16 v[202:203], v17 offset:13312
    v_mfma_f32_32x32x16_bf16 v[176:191], v[204:207], v[108:111], v[176:191]
    ds_read_b64_tr_b16 v[204:205], v17 offset:14336
    ds_read_b64_tr_b16 v[206:207], v17 offset:15360
    v_cvt_pk_bf16_f32 v240, v160, v161
    v_cvt_pk_bf16_f32 v241, v162, v163
    v_cvt_pk_bf16_f32 v242, v164, v165
    v_cvt_pk_bf16_f32 v243, v166, v167
    s_waitcnt lgkmcnt(15)
    v_mfma_f32_32x32x16_bf16 v[176:191], v[208:211], v[112:115], v[176:191]
    v_cvt_pk_bf16_f32 v244, v168, v169
    v_cvt_pk_bf16_f32 v245, v170, v171
    v_cvt_pk_bf16_f32 v246, v172, v173
    v_cvt_pk_bf16_f32 v247, v174, v175
    v_mfma_f32_32x32x16_bf16 v[176:191], v[212:215], v[116:119], v[176:191]
    s_mov_b32 s59, 32768
    buffer_store_dwordx4 v[240:243], v18, s[28:31], s59 offen sc1
    buffer_store_dwordx4 v[244:247], v18, s[28:31], s59 offen offset:1024 sc1
    v_mfma_f32_32x32x16_bf16 v[176:191], v[216:219], v[120:123], v[176:191]
    v_mfma_f32_32x32x16_bf16 v[176:191], v[220:223], v[124:127], v[176:191]
    s_waitcnt vmcnt(7)
    s_mov_b32 s59, 1024
    buffer_store_dwordx2 v[20:21], v19, s[44:47], s59 offen sc1
    s_waitcnt lgkmcnt(0)
    s_barrier
    v_add_u32 v16, 98304, v11
    v_xor_b32 v17, 16384, v16
    ds_read_b64_tr_b16 v[208:209], v16 offset:0
    ds_read_b64_tr_b16 v[210:211], v16 offset:1024
    ds_read_b64_tr_b16 v[212:213], v16 offset:2048
    v_mfma_f32_32x32x16_bf16 v[176:191], v[224:227], v[128:131], v[176:191]
    ds_read_b64_tr_b16 v[214:215], v16 offset:3072
    ds_read_b64_tr_b16 v[216:217], v16 offset:4096
    ds_read_b64_tr_b16 v[218:219], v16 offset:5120
    s_add_u32 m0, s55, 0
    s_mov_b32 s58, 768
    buffer_load_dwordx4 v6, s[24:27], s58 offen lds
    v_lshrrev_b32 v27, 4, v12
    v_lshrrev_b32 v22, 5, v27
    v_and_b32 v27, 31, v27
    v_and_b32 v23, 3, v27
    v_mfma_f32_32x32x16_bf16 v[176:191], v[228:231], v[132:135], v[176:191]
    ds_read_b64_tr_b16 v[220:221], v16 offset:6144
    ds_read_b64_tr_b16 v[222:223], v16 offset:7168
    ds_read_b64_tr_b16 v[224:225], v16 offset:8192
    buffer_load_dwordx4 v28, s[24:27], s58 offen offset:1024 lds
    v_bfe_u32 v25, v27, 3, 1
    v_lshl_or_b32 v23, v25, 2, v23
    v_bfe_u32 v25, v27, 2, 1
    v_lshl_or_b32 v23, v25, 3, v23
    v_mfma_f32_32x32x16_bf16 v[176:191], v[232:235], v[136:139], v[176:191]
    ds_read_b64_tr_b16 v[226:227], v16 offset:9216
    ds_read_b64_tr_b16 v[228:229], v16 offset:10240
    ds_read_b64_tr_b16 v[230:231], v16 offset:11264
    buffer_load_dwordx4 v29, s[24:27], s58 offen offset:2048 lds
    v_and_b32 v25, 16, v27
    v_or_b32 v23, v23, v25
    v_lshlrev_b32 v25, 3, v22
    v_sub_u32 v23, v23, v25
    v_mfma_f32_32x32x16_bf16 v[176:191], v[236:239], v[140:143], v[176:191]
    ds_read_b64_tr_b16 v[232:233], v16 offset:12288
    ds_read_b64_tr_b16 v[234:235], v16 offset:13312
    ds_read_b64_tr_b16 v[236:237], v16 offset:14336
    buffer_load_dwordx4 v30, s[24:27], s58 offen offset:3072 lds
    v_and_b32 v25, 1, v23
    v_lshlrev_b32 v25, 4, v25
    v_mov_b32 v26, 0x3f80
    v_lshlrev_b32 v25, v25, v26
    v_mfma_f32_32x32x16_bf16 v[176:191], v[192:195], v[144:147], v[176:191]
    ds_read_b64_tr_b16 v[238:239], v16 offset:15360
    ds_read_b64_tr_b16 v[192:193], v17 offset:0
    ds_read_b64_tr_b16 v[194:195], v17 offset:1024
    v_lshrrev_b32 v23, 1, v23
    v_cmp_eq_u32 vcc, 0, v23
    s_nop 1
    v_cndmask_b32 v248, 0, v25, vcc
    v_mfma_f32_32x32x16_bf16 v[176:191], v[196:199], v[148:151], v[176:191]
    ds_read_b64_tr_b16 v[196:197], v17 offset:2048
    ds_read_b64_tr_b16 v[198:199], v17 offset:3072
    v_cmp_eq_u32 vcc, 1, v23
    s_nop 1
    v_cndmask_b32 v249, 0, v25, vcc
    v_cmp_eq_u32 vcc, 2, v23
    v_mfma_f32_32x32x16_bf16 v[176:191], v[200:203], v[152:155], v[176:191]
    ds_read_b64_tr_b16 v[200:201], v17 offset:4096
    ds_read_b64_tr_b16 v[202:203], v17 offset:5120
    s_nop 1
    v_cndmask_b32 v250, 0, v25, vcc
    v_cmp_eq_u32 vcc, 3, v23
    s_nop 1
    v_mfma_f32_32x32x16_bf16 v[176:191], v[204:207], v[156:159], v[176:191]
    ds_read_b64_tr_b16 v[204:205], v17 offset:6144
    ds_read_b64_tr_b16 v[206:207], v17 offset:7168
    v_cndmask_b32 v251, 0, v25, vcc
    s_bfe_u32 s3, s61, 0x20001
    s_lshl_b32 s3, s3, 5
    v_add_u32 v27, s3, v27
    s_waitcnt lgkmcnt(15)
    v_mfma_f32_32x32x16_bf16 v[160:175], v[208:211], v[96:99], 0
    ds_read_b64_tr_b16 v[208:209], v17 offset:8192
    ds_read_b64_tr_b16 v[210:211], v17 offset:9216
    v_cmp_le_u32 vcc, 112, v27
    v_mov_b32 v23, 1073741824
    s_nop 0
    v_cndmask_b32 v23, 0, v23, vcc
    v_mfma_f32_32x32x16_bf16 v[160:175], v[212:215], v[100:103], v[160:175]
    ds_read_b64_tr_b16 v[212:213], v17 offset:10240
    ds_read_b64_tr_b16 v[214:215], v17 offset:11264
    s_lshl_b32 s3, s40, 14
    s_lshl_b32 s4, s61, 10
    s_add_u32 s3, s3, s4
    v_add_u32 v25, s3, v12
    v_mfma_f32_32x32x16_bf16 v[160:175], v[216:219], v[104:107], v[160:175]
    ds_read_b64_tr_b16 v[216:217], v17 offset:12288
    ds_read_b64_tr_b16 v[218:219], v17 offset:13312
    v_mfma_f32_32x32x16_bf16 v[160:175], v[220:223], v[108:111], v[160:175]
    ds_read_b64_tr_b16 v[220:221], v17 offset:14336
    ds_read_b64_tr_b16 v[222:223], v17 offset:15360
    v_cvt_pk_bf16_f32 v240, v176, v177
    v_cvt_pk_bf16_f32 v241, v178, v179
    v_cvt_pk_bf16_f32 v242, v180, v181
    v_cvt_pk_bf16_f32 v243, v182, v183
    s_waitcnt lgkmcnt(15)
    v_mfma_f32_32x32x16_bf16 v[160:175], v[224:227], v[112:115], v[160:175]
    v_cvt_pk_bf16_f32 v244, v184, v185
    v_cvt_pk_bf16_f32 v245, v186, v187
    v_cvt_pk_bf16_f32 v246, v188, v189
    v_cvt_pk_bf16_f32 v247, v190, v191
    v_mfma_f32_32x32x16_bf16 v[160:175], v[228:231], v[116:119], v[160:175]
    s_mov_b32 s59, 49152
    buffer_store_dwordx4 v[240:243], v18, s[28:31], s59 offen sc1
    buffer_store_dwordx4 v[244:247], v18, s[28:31], s59 offen offset:1024 sc1
    v_mfma_f32_32x32x16_bf16 v[160:175], v[232:235], v[120:123], v[160:175]
    v_mfma_f32_32x32x16_bf16 v[160:175], v[236:239], v[124:127], v[160:175]
    s_waitcnt vmcnt(7)
    s_mov_b32 s59, 2048
    buffer_store_dwordx2 v[20:21], v19, s[44:47], s59 offen sc1
    s_waitcnt lgkmcnt(0)
    s_barrier
    v_add_u32 v16, 131072, v11
    v_xor_b32 v17, 16384, v16
    ds_read_b64_tr_b16 v[224:225], v16 offset:0
    ds_read_b64_tr_b16 v[226:227], v16 offset:1024
    ds_read_b64_tr_b16 v[228:229], v16 offset:2048
    v_mfma_f32_32x32x16_bf16 v[160:175], v[192:195], v[128:131], v[160:175]
    ds_read_b64_tr_b16 v[230:231], v16 offset:3072
    ds_read_b64_tr_b16 v[232:233], v16 offset:4096
    ds_read_b64_tr_b16 v[234:235], v16 offset:5120
    s_add_u32 m0, s55, 32768
    s_mov_b32 s58, 896
    buffer_load_dwordx4 v6, s[24:27], s58 offen lds
    v_or_b32 v25, v25, v23
    s_mul_i32 s3, s62, 112
    v_add_u32 v27, s3, v27
    v_lshlrev_b32 v27, 11, v27
    v_mfma_f32_32x32x16_bf16 v[160:175], v[196:199], v[132:135], v[160:175]
    ds_read_b64_tr_b16 v[236:237], v16 offset:6144
    ds_read_b64_tr_b16 v[238:239], v16 offset:7168
    ds_read_b64_tr_b16 v[192:193], v16 offset:8192
    buffer_load_dwordx4 v28, s[24:27], s58 offen offset:1024 lds
    s_lshl_b32 s3, s63, 10
    s_lshl_b32 s4, s40, 7
    s_add_u32 s3, s3, s4
    s_lshr_b32 s4, s61, 3
    v_mfma_f32_32x32x16_bf16 v[160:175], v[200:203], v[136:139], v[160:175]
    ds_read_b64_tr_b16 v[194:195], v16 offset:9216
    ds_read_b64_tr_b16 v[196:197], v16 offset:10240
    ds_read_b64_tr_b16 v[198:199], v16 offset:11264
    buffer_load_dwordx4 v29, s[24:27], s58 offen offset:2048 lds
    s_lshl_b32 s4, s4, 6
    s_add_u32 s3, s3, s4
    s_and_b32 s4, s61, 1
    s_lshl_b32 s4, s4, 5
    v_mfma_f32_32x32x16_bf16 v[160:175], v[204:207], v[140:143], v[160:175]
    ds_read_b64_tr_b16 v[200:201], v16 offset:12288
    ds_read_b64_tr_b16 v[202:203], v16 offset:13312
    ds_read_b64_tr_b16 v[204:205], v16 offset:14336
    buffer_load_dwordx4 v30, s[24:27], s58 offen offset:3072 lds
    s_add_u32 s3, s3, s4
    v_lshlrev_b32 v22, 4, v22
    v_add_u32 v27, v27, v22
    v_add_u32 v27, s3, v27
    v_mfma_f32_32x32x16_bf16 v[160:175], v[208:211], v[144:147], v[160:175]
    ds_read_b64_tr_b16 v[206:207], v16 offset:15360
    ds_read_b64_tr_b16 v[208:209], v17 offset:0
    ds_read_b64_tr_b16 v[210:211], v17 offset:1024
    v_or_b32 v26, v27, v23
    s_lshl_b32 s3, s40, 10
    s_lshr_b32 s4, s61, 1
    s_lshl_b32 s4, s4, 7
    v_mfma_f32_32x32x16_bf16 v[160:175], v[212:215], v[148:151], v[160:175]
    ds_read_b64_tr_b16 v[212:213], v17 offset:2048
    ds_read_b64_tr_b16 v[214:215], v17 offset:3072
    s_add_u32 s3, s3, s4
    v_lshrrev_b32 v27, 1, v12
    v_add_u32 v24, s3, v27
    v_and_b32 v27, 0x300, v12
    v_mfma_f32_32x32x16_bf16 v[160:175], v[216:219], v[152:155], v[160:175]
    ds_read_b64_tr_b16 v[216:217], v17 offset:4096
    ds_read_b64_tr_b16 v[218:219], v17 offset:5120
    v_min_u32 v27, 1, v27
    v_lshlrev_b32 v27, 30, v27
    v_or_b32 v24, v24, v27
    v_mfma_f32_32x32x16_bf16 v[160:175], v[220:223], v[156:159], v[160:175]
    ds_read_b64_tr_b16 v[220:221], v17 offset:6144
    ds_read_b64_tr_b16 v[222:223], v17 offset:7168
    s_waitcnt lgkmcnt(15)
    v_mfma_f32_32x32x16_bf16 v[176:191], v[224:227], v[96:99], 0
    ds_read_b64_tr_b16 v[224:225], v17 offset:8192
    ds_read_b64_tr_b16 v[226:227], v17 offset:9216
    v_mfma_f32_32x32x16_bf16 v[176:191], v[228:231], v[100:103], v[176:191]
    ds_read_b64_tr_b16 v[228:229], v17 offset:10240
    ds_read_b64_tr_b16 v[230:231], v17 offset:11264
    v_mfma_f32_32x32x16_bf16 v[176:191], v[232:235], v[104:107], v[176:191]
    ds_read_b64_tr_b16 v[232:233], v17 offset:12288
    ds_read_b64_tr_b16 v[234:235], v17 offset:13312
    v_mfma_f32_32x32x16_bf16 v[176:191], v[236:239], v[108:111], v[176:191]
    ds_read_b64_tr_b16 v[236:237], v17 offset:14336
    ds_read_b64_tr_b16 v[238:239], v17 offset:15360
    v_cvt_pk_bf16_f32 v240, v160, v161
    v_cvt_pk_bf16_f32 v241, v162, v163
    v_cvt_pk_bf16_f32 v242, v164, v165
    v_cvt_pk_bf16_f32 v243, v166, v167
    s_waitcnt lgkmcnt(15)
    v_mfma_f32_32x32x16_bf16 v[176:191], v[192:195], v[112:115], v[176:191]
    v_cvt_pk_bf16_f32 v244, v168, v169
    v_cvt_pk_bf16_f32 v245, v170, v171
    v_cvt_pk_bf16_f32 v246, v172, v173
    v_cvt_pk_bf16_f32 v247, v174, v175
    v_mfma_f32_32x32x16_bf16 v[176:191], v[196:199], v[116:119], v[176:191]
    s_mov_b32 s59, 65536
    buffer_store_dwordx4 v[240:243], v18, s[28:31], s59 offen sc1
    buffer_store_dwordx4 v[244:247], v18, s[28:31], s59 offen offset:1024 sc1
    v_mfma_f32_32x32x16_bf16 v[176:191], v[200:203], v[120:123], v[176:191]
    v_mfma_f32_32x32x16_bf16 v[176:191], v[204:207], v[124:127], v[176:191]
    s_waitcnt vmcnt(7)
    s_mov_b32 s59, 3072
    buffer_store_dwordx2 v[20:21], v19, s[44:47], s59 offen sc1
    s_waitcnt lgkmcnt(0)
    s_barrier
    v_add_u32 v16, 0, v11
    v_xor_b32 v17, 16384, v16
    ds_read_b64_tr_b16 v[192:193], v16 offset:0
    ds_read_b64_tr_b16 v[194:195], v16 offset:1024
    ds_read_b64_tr_b16 v[196:197], v16 offset:2048
    v_mfma_f32_32x32x16_bf16 v[176:191], v[208:211], v[128:131], v[176:191]
    ds_read_b64_tr_b16 v[198:199], v16 offset:3072
    ds_read_b64_tr_b16 v[200:201], v16 offset:4096
    ds_read_b64_tr_b16 v[202:203], v16 offset:5120
    v_mfma_f32_32x32x16_bf16 v[176:191], v[212:215], v[132:135], v[176:191]
    ds_read_b64_tr_b16 v[204:205], v16 offset:6144
    ds_read_b64_tr_b16 v[206:207], v16 offset:7168
    ds_read_b64_tr_b16 v[208:209], v16 offset:8192
    v_mfma_f32_32x32x16_bf16 v[176:191], v[216:219], v[136:139], v[176:191]
    ds_read_b64_tr_b16 v[210:211], v16 offset:9216
    ds_read_b64_tr_b16 v[212:213], v16 offset:10240
    ds_read_b64_tr_b16 v[214:215], v16 offset:11264
    v_mfma_f32_32x32x16_bf16 v[176:191], v[220:223], v[140:143], v[176:191]
    ds_read_b64_tr_b16 v[216:217], v16 offset:12288
    ds_read_b64_tr_b16 v[218:219], v16 offset:13312
    ds_read_b64_tr_b16 v[220:221], v16 offset:14336
    v_mfma_f32_32x32x16_bf16 v[176:191], v[224:227], v[144:147], v[176:191]
    ds_read_b64_tr_b16 v[222:223], v16 offset:15360
    ds_read_b64_tr_b16 v[224:225], v17 offset:0
    ds_read_b64_tr_b16 v[226:227], v17 offset:1024
    v_mfma_f32_32x32x16_bf16 v[176:191], v[228:231], v[148:151], v[176:191]
    ds_read_b64_tr_b16 v[228:229], v17 offset:2048
    ds_read_b64_tr_b16 v[230:231], v17 offset:3072
    v_mfma_f32_32x32x16_bf16 v[176:191], v[232:235], v[152:155], v[176:191]
    ds_read_b64_tr_b16 v[232:233], v17 offset:4096
    ds_read_b64_tr_b16 v[234:235], v17 offset:5120
    v_mfma_f32_32x32x16_bf16 v[176:191], v[236:239], v[156:159], v[176:191]
    ds_read_b64_tr_b16 v[236:237], v17 offset:6144
    ds_read_b64_tr_b16 v[238:239], v17 offset:7168
    s_waitcnt lgkmcnt(15)
    v_mfma_f32_32x32x16_bf16 v[160:175], v[192:195], v[96:99], 0
    ds_read_b64_tr_b16 v[192:193], v17 offset:8192
    ds_read_b64_tr_b16 v[194:195], v17 offset:9216
    v_mfma_f32_32x32x16_bf16 v[160:175], v[196:199], v[100:103], v[160:175]
    ds_read_b64_tr_b16 v[196:197], v17 offset:10240
    ds_read_b64_tr_b16 v[198:199], v17 offset:11264
    v_mfma_f32_32x32x16_bf16 v[160:175], v[200:203], v[104:107], v[160:175]
    ds_read_b64_tr_b16 v[200:201], v17 offset:12288
    ds_read_b64_tr_b16 v[202:203], v17 offset:13312
    v_mfma_f32_32x32x16_bf16 v[160:175], v[204:207], v[108:111], v[160:175]
    ds_read_b64_tr_b16 v[204:205], v17 offset:14336
    ds_read_b64_tr_b16 v[206:207], v17 offset:15360
    v_cvt_pk_bf16_f32 v240, v176, v177
    v_cvt_pk_bf16_f32 v241, v178, v179
    v_cvt_pk_bf16_f32 v242, v180, v181
    v_cvt_pk_bf16_f32 v243, v182, v183
    s_waitcnt lgkmcnt(15)
    v_mfma_f32_32x32x16_bf16 v[160:175], v[208:211], v[112:115], v[160:175]
    v_cvt_pk_bf16_f32 v244, v184, v185
    v_cvt_pk_bf16_f32 v245, v186, v187
    v_cvt_pk_bf16_f32 v246, v188, v189
    v_cvt_pk_bf16_f32 v247, v190, v191
    v_mfma_f32_32x32x16_bf16 v[160:175], v[212:215], v[116:119], v[160:175]
    s_mov_b32 s59, 81920
    buffer_store_dwordx4 v[240:243], v18, s[28:31], s59 offen sc1
    buffer_store_dwordx4 v[244:247], v18, s[28:31], s59 offen offset:1024 sc1
    v_mfma_f32_32x32x16_bf16 v[160:175], v[216:219], v[120:123], v[160:175]
    v_mfma_f32_32x32x16_bf16 v[160:175], v[220:223], v[124:127], v[160:175]
    s_waitcnt vmcnt(3)
    s_mov_b32 s59, 4096
    buffer_store_dwordx2 v[20:21], v19, s[44:47], s59 offen sc1
    s_waitcnt lgkmcnt(0)
    s_barrier
    v_add_u32 v16, 32768, v11
    v_xor_b32 v17, 16384, v16
    ds_read_b64_tr_b16 v[208:209], v16 offset:0
    ds_read_b64_tr_b16 v[210:211], v16 offset:1024
    ds_read_b64_tr_b16 v[212:213], v16 offset:2048
    v_mfma_f32_32x32x16_bf16 v[160:175], v[224:227], v[128:131], v[160:175]
    ds_read_b64_tr_b16 v[214:215], v16 offset:3072
    ds_read_b64_tr_b16 v[216:217], v16 offset:4096
    ds_read_b64_tr_b16 v[218:219], v16 offset:5120
    v_mfma_f32_32x32x16_bf16 v[160:175], v[228:231], v[132:135], v[160:175]
    ds_read_b64_tr_b16 v[220:221], v16 offset:6144
    ds_read_b64_tr_b16 v[222:223], v16 offset:7168
    ds_read_b64_tr_b16 v[224:225], v16 offset:8192
    buffer_load_dwordx2 v[22:23], v24, s[44:47], 0 offen sc1
    v_mfma_f32_32x32x16_bf16 v[160:175], v[232:235], v[136:139], v[160:175]
    ds_read_b64_tr_b16 v[226:227], v16 offset:9216
    ds_read_b64_tr_b16 v[228:229], v16 offset:10240
    ds_read_b64_tr_b16 v[230:231], v16 offset:11264
    v_mfma_f32_32x32x16_bf16 v[160:175], v[236:239], v[140:143], v[160:175]
    ds_read_b64_tr_b16 v[232:233], v16 offset:12288
    ds_read_b64_tr_b16 v[234:235], v16 offset:13312
    ds_read_b64_tr_b16 v[236:237], v16 offset:14336
    v_mfma_f32_32x32x16_bf16 v[160:175], v[192:195], v[144:147], v[160:175]
    ds_read_b64_tr_b16 v[238:239], v16 offset:15360
    ds_read_b64_tr_b16 v[192:193], v17 offset:0
    ds_read_b64_tr_b16 v[194:195], v17 offset:1024
    v_mfma_f32_32x32x16_bf16 v[160:175], v[196:199], v[148:151], v[160:175]
    ds_read_b64_tr_b16 v[196:197], v17 offset:2048
    ds_read_b64_tr_b16 v[198:199], v17 offset:3072
    v_mfma_f32_32x32x16_bf16 v[160:175], v[200:203], v[152:155], v[160:175]
    ds_read_b64_tr_b16 v[200:201], v17 offset:4096
    ds_read_b64_tr_b16 v[202:203], v17 offset:5120
    v_mfma_f32_32x32x16_bf16 v[160:175], v[204:207], v[156:159], v[160:175]
    ds_read_b64_tr_b16 v[204:205], v17 offset:6144
    ds_read_b64_tr_b16 v[206:207], v17 offset:7168
    s_waitcnt lgkmcnt(15)
    v_mfma_f32_32x32x16_bf16 v[176:191], v[208:211], v[96:99], 0
    ds_read_b64_tr_b16 v[208:209], v17 offset:8192
    ds_read_b64_tr_b16 v[210:211], v17 offset:9216
    v_mfma_f32_32x32x16_bf16 v[176:191], v[212:215], v[100:103], v[176:191]
    ds_read_b64_tr_b16 v[212:213], v17 offset:10240
    ds_read_b64_tr_b16 v[214:215], v17 offset:11264
    v_mfma_f32_32x32x16_bf16 v[176:191], v[216:219], v[104:107], v[176:191]
    ds_read_b64_tr_b16 v[216:217], v17 offset:12288
    ds_read_b64_tr_b16 v[218:219], v17 offset:13312
    v_mfma_f32_32x32x16_bf16 v[176:191], v[220:223], v[108:111], v[176:191]
    ds_read_b64_tr_b16 v[220:221], v17 offset:14336
    ds_read_b64_tr_b16 v[222:223], v17 offset:15360
    v_cvt_pk_bf16_f32 v240, v160, v161
    v_cvt_pk_bf16_f32 v241, v162, v163
    v_cvt_pk_bf16_f32 v242, v164, v165
    v_cvt_pk_bf16_f32 v243, v166, v167
    s_waitcnt lgkmcnt(15)
    v_mfma_f32_32x32x16_bf16 v[176:191], v[224:227], v[112:115], v[176:191]
    v_cvt_pk_bf16_f32 v244, v168, v169
    v_cvt_pk_bf16_f32 v245, v170, v171
    v_cvt_pk_bf16_f32 v246, v172, v173
    v_cvt_pk_bf16_f32 v247, v174, v175
    v_mfma_f32_32x32x16_bf16 v[176:191], v[228:231], v[116:119], v[176:191]
    s_mov_b32 s59, 98304
    buffer_store_dwordx4 v[240:243], v18, s[28:31], s59 offen sc1
    buffer_store_dwordx4 v[244:247], v18, s[28:31], s59 offen offset:1024 sc1
    v_mfma_f32_32x32x16_bf16 v[176:191], v[232:235], v[120:123], v[176:191]
    v_mfma_f32_32x32x16_bf16 v[176:191], v[236:239], v[124:127], v[176:191]
    s_waitcnt lgkmcnt(14)
    v_mfma_f32_32x32x16_bf16 v[176:191], v[192:195], v[128:131], v[176:191]
    s_waitcnt lgkmcnt(12)
    v_mfma_f32_32x32x16_bf16 v[176:191], v[196:199], v[132:135], v[176:191]
    s_waitcnt lgkmcnt(10)
    v_mfma_f32_32x32x16_bf16 v[176:191], v[200:203], v[136:139], v[176:191]
    s_waitcnt lgkmcnt(8)
    v_mfma_f32_32x32x16_bf16 v[176:191], v[204:207], v[140:143], v[176:191]
    s_waitcnt lgkmcnt(6)
    v_mfma_f32_32x32x16_bf16 v[176:191], v[208:211], v[144:147], v[176:191]
    s_waitcnt lgkmcnt(4)
    v_mfma_f32_32x32x16_bf16 v[176:191], v[212:215], v[148:151], v[176:191]
    s_waitcnt lgkmcnt(2)
    v_mfma_f32_32x32x16_bf16 v[176:191], v[216:219], v[152:155], v[176:191]
    s_waitcnt lgkmcnt(0)
    v_mfma_f32_32x32x16_bf16 v[176:191], v[220:223], v[156:159], v[176:191]
    s_waitcnt vmcnt(2)
    v_cmp_eq_u64 vcc, v[22:23], v[20:21]
    s_nop 1
    s_and_b32 s3, vcc_lo, 0xffff
    s_cmp_eq_u32 s3, 0xffff
    s_cselect_b32 s43, 1, 0
    s_nop 5
    v_cvt_pk_bf16_f32 v240, v176, v177
    v_cvt_pk_bf16_f32 v241, v178, v179
    v_cvt_pk_bf16_f32 v242, v180, v181
    v_cvt_pk_bf16_f32 v243, v182, v183
    v_cvt_pk_bf16_f32 v244, v184, v185
    v_cvt_pk_bf16_f32 v245, v186, v187
    v_cvt_pk_bf16_f32 v246, v188, v189
    v_cvt_pk_bf16_f32 v247, v190, v191
    s_mov_b32 s59, 114688
    buffer_store_dwordx4 v[240:243], v18, s[28:31], s59 offen sc1
    buffer_store_dwordx4 v[244:247], v18, s[28:31], s59 offen offset:1024 sc1
    s_cmp_eq_u32 s43, 1
    s_cbranch_scc0 TAILF
    s_mov_b32 s59, 0
    buffer_load_dwordx4 v[32:35], v25, s[32:35], s59 offen sc1
    s_mov_b32 s59, 131072
    buffer_load_dwordx4 v[36:39], v25, s[32:35], s59 offen sc1
    s_mov_b32 s59, 262144
    buffer_load_dwordx4 v[40:43], v25, s[32:35], s59 offen sc1
    s_mov_b32 s59, 393216
    buffer_load_dwordx4 v[44:47], v25, s[32:35], s59 offen sc1
    s_mov_b32 s59, 524288
    buffer_load_dwordx4 v[48:51], v25, s[32:35], s59 offen sc1
    s_mov_b32 s59, 655360
    buffer_load_dwordx4 v[52:55], v25, s[32:35], s59 offen sc1
    s_mov_b32 s59, 786432
    buffer_load_dwordx4 v[56:59], v25, s[32:35], s59 offen sc1
    s_mov_b32 s59, 917504
    buffer_load_dwordx4 v[60:63], v25, s[32:35], s59 offen sc1
    s_mov_b32 s59, 1048576
    buffer_load_dwordx4 v[64:67], v25, s[32:35], s59 offen sc1
    s_mov_b32 s59, 1179648
    buffer_load_dwordx4 v[68:71], v25, s[32:35], s59 offen sc1
    s_mov_b32 s59, 1310720
    buffer_load_dwordx4 v[72:75], v25, s[32:35], s59 offen sc1
    s_mov_b32 s59, 1441792
    buffer_load_dwordx4 v[76:79], v25, s[32:35], s59 offen sc1
    s_mov_b32 s59, 1572864
    buffer_load_dwordx4 v[80:83], v25, s[32:35], s59 offen sc1
    s_mov_b32 s59, 1703936
    buffer_load_dwordx4 v[84:87], v25, s[32:35], s59 offen sc1
    s_mov_b32 s59, 1835008
    buffer_load_dwordx4 v[88:91], v25, s[32:35], s59 offen sc1
    s_mov_b32 s59, 1966080
    buffer_load_dwordx4 v[92:95], v25, s[32:35], s59 offen sc1
    s_mov_b32 s59, 5120
    buffer_store_dwordx2 v[20:21], v19, s[44:47], s59 offen sc1
    s_waitcnt vmcnt(19)
    s_mov_b32 s59, 6144
    buffer_store_dwordx2 v[20:21], v19, s[44:47], s59 offen sc1
    s_waitcnt vmcnt(18)
    s_mov_b32 s59, 7168
    buffer_store_dwordx2 v[20:21], v19, s[44:47], s59 offen sc1
    s_waitcnt vmcnt(18)
    v_mfma_f32_32x32x16_bf16 v[160:175], v[248:251], v[32:35], 0
    s_waitcnt vmcnt(17)
    v_mfma_f32_32x32x16_bf16 v[160:175], v[248:251], v[36:39], v[160:175]
    s_waitcnt vmcnt(16)
    v_mfma_f32_32x32x16_bf16 v[160:175], v[248:251], v[40:43], v[160:175]
    s_waitcnt vmcnt(15)
    v_mfma_f32_32x32x16_bf16 v[160:175], v[248:251], v[44:47], v[160:175]
    s_waitcnt vmcnt(14)
    v_mfma_f32_32x32x16_bf16 v[160:175], v[248:251], v[48:51], v[160:175]
    s_waitcnt vmcnt(13)
    v_mfma_f32_32x32x16_bf16 v[160:175], v[248:251], v[52:55], v[160:175]
    s_waitcnt vmcnt(12)
    v_mfma_f32_32x32x16_bf16 v[160:175], v[248:251], v[56:59], v[160:175]
    s_waitcnt vmcnt(11)
    v_mfma_f32_32x32x16_bf16 v[160:175], v[248:251], v[60:63], v[160:175]
    s_waitcnt vmcnt(10)
    v_mfma_f32_32x32x16_bf16 v[160:175], v[248:251], v[64:67], v[160:175]
    s_waitcnt vmcnt(9)
    v_mfma_f32_32x32x16_bf16 v[160:175], v[248:251], v[68:71], v[160:175]
    s_waitcnt vmcnt(8)
    v_mfma_f32_32x32x16_bf16 v[160:175], v[248:251], v[72:75], v[160:175]
    s_waitcnt vmcnt(7)
    v_mfma_f32_32x32x16_bf16 v[160:175], v[248:251], v[76:79], v[160:175]
    s_waitcnt vmcnt(6)
    v_mfma_f32_32x32x16_bf16 v[160:175], v[248:251], v[80:83], v[160:175]
    s_waitcnt vmcnt(5)
    v_mfma_f32_32x32x16_bf16 v[160:175], v[248:251], v[84:87], v[160:175]
    s_waitcnt vmcnt(4)
    v_mfma_f32_32x32x16_bf16 v[160:175], v[248:251], v[88:91], v[160:175]
    s_waitcnt vmcnt(3)
    v_mfma_f32_32x32x16_bf16 v[160:175], v[248:251], v[92:95], v[160:175]
    s_nop 11
    v_cvt_pk_bf16_f32 v240, v160, v161
    v_cvt_pk_bf16_f32 v241, v162, v163
    v_cvt_pk_bf16_f32 v242, v164, v165
    v_cvt_pk_bf16_f32 v243, v166, v167
    buffer_store_dwordx4 v[240:243], v26, s[36:39], 0 offen
    s_branch TAILEND
TAILF:
    s_mov_b32 s59, 5120
    buffer_store_dwordx2 v[20:21], v19, s[44:47], s59 offen sc1
    s_waitcnt vmcnt(3)
    s_mov_b32 s59, 6144
    buffer_store_dwordx2 v[20:21], v19, s[44:47], s59 offen sc1
    s_waitcnt vmcnt(2)
    s_mov_b32 s59, 7168
    buffer_store_dwordx2 v[20:21], v19, s[44:47], s59 offen sc1
    s_mov_b32 s91, 0
POLL:
    buffer_load_dwordx2 v[22:23], v24, s[44:47], 0 offen sc1
    s_add_u32 s91, s91, 1
    s_waitcnt vmcnt(0)
    v_cmp_eq_u64 vcc, v[22:23], v[20:21]
    s_nop 1
    s_and_b32 s3, vcc_lo, 0xffff
    s_cmp_eq_u32 s3, 0xffff
    s_cbranch_scc1 POLLOK
    s_cmp_lt_u32 s91, 0x8000
    s_cbranch_scc1 POLL
POLLOK:
    s_mov_b32 s59, 0
    buffer_load_dwordx4 v[32:35], v25, s[32:35], s59 offen sc1
    s_mov_b32 s59, 131072
    buffer_load_dwordx4 v[36:39], v25, s[32:35], s59 offen sc1
    s_mov_b32 s59, 262144
    buffer_load_dwordx4 v[40:43], v25, s[32:35], s59 offen sc1
    s_mov_b32 s59, 393216
    buffer_load_dwordx4 v[44:47], v25, s[32:35], s59 offen sc1
    s_mov_b32 s59, 524288
    buffer_load_dwordx4 v[48:51], v25, s[32:35], s59 offen sc1
    s_mov_b32 s59, 655360
    buffer_load_dwordx4 v[52:55], v25, s[32:35], s59 offen sc1
    s_mov_b32 s59, 786432
    buffer_load_dwordx4 v[56:59], v25, s[32:35], s59 offen sc1
    s_mov_b32 s59, 917504
    buffer_load_dwordx4 v[60:63], v25, s[32:35], s59 offen sc1
    s_mov_b32 s59, 1048576
    buffer_load_dwordx4 v[64:67], v25, s[32:35], s59 offen sc1
    s_mov_b32 s59, 1179648
    buffer_load_dwordx4 v[68:71], v25, s[32:35], s59 offen sc1
    s_mov_b32 s59, 1310720
    buffer_load_dwordx4 v[72:75], v25, s[32:35], s59 offen sc1
    s_mov_b32 s59, 1441792
    buffer_load_dwordx4 v[76:79], v25, s[32:35], s59 offen sc1
    s_mov_b32 s59, 1572864
    buffer_load_dwordx4 v[80:83], v25, s[32:35], s59 offen sc1
    s_mov_b32 s59, 1703936
    buffer_load_dwordx4 v[84:87], v25, s[32:35], s59 offen sc1
    s_mov_b32 s59, 1835008
    buffer_load_dwordx4 v[88:91], v25, s[32:35], s59 offen sc1
    s_mov_b32 s59, 1966080
    buffer_load_dwordx4 v[92:95], v25, s[32:35], s59 offen sc1
    s_waitcnt vmcnt(15)
    v_mfma_f32_32x32x16_bf16 v[160:175], v[248:251], v[32:35], 0
    s_waitcnt vmcnt(14)
    v_mfma_f32_32x32x16_bf16 v[160:175], v[248:251], v[36:39], v[160:175]
    s_waitcnt vmcnt(13)
    v_mfma_f32_32x32x16_bf16 v[160:175], v[248:251], v[40:43], v[160:175]
    s_waitcnt vmcnt(12)
    v_mfma_f32_32x32x16_bf16 v[160:175], v[248:251], v[44:47], v[160:175]
    s_waitcnt vmcnt(11)
    v_mfma_f32_32x32x16_bf16 v[160:175], v[248:251], v[48:51], v[160:175]
    s_waitcnt vmcnt(10)
    v_mfma_f32_32x32x16_bf16 v[160:175], v[248:251], v[52:55], v[160:175]
    s_waitcnt vmcnt(9)
    v_mfma_f32_32x32x16_bf16 v[160:175], v[248:251], v[56:59], v[160:175]
    s_waitcnt vmcnt(8)
    v_mfma_f32_32x32x16_bf16 v[160:175], v[248:251], v[60:63], v[160:175]
    s_waitcnt vmcnt(7)
    v_mfma_f32_32x32x16_bf16 v[160:175], v[248:251], v[64:67], v[160:175]
    s_waitcnt vmcnt(6)
    v_mfma_f32_32x32x16_bf16 v[160:175], v[248:251], v[68:71], v[160:175]
    s_waitcnt vmcnt(5)
    v_mfma_f32_32x32x16_bf16 v[160:175], v[248:251], v[72:75], v[160:175]
    s_waitcnt vmcnt(4)
    v_mfma_f32_32x32x16_bf16 v[160:175], v[248:251], v[76:79], v[160:175]
    s_waitcnt vmcnt(3)
    v_mfma_f32_32x32x16_bf16 v[160:175], v[248:251], v[80:83], v[160:175]
    s_waitcnt vmcnt(2)
    v_mfma_f32_32x32x16_bf16 v[160:175], v[248:251], v[84:87], v[160:175]
    s_waitcnt vmcnt(1)
    v_mfma_f32_32x32x16_bf16 v[160:175], v[248:251], v[88:91], v[160:175]
    s_waitcnt vmcnt(0)
    v_mfma_f32_32x32x16_bf16 v[160:175], v[248:251], v[92:95], v[160:175]
    s_nop 11
    v_cvt_pk_bf16_f32 v240, v160, v161
    v_cvt_pk_bf16_f32 v241, v162, v163
    v_cvt_pk_bf16_f32 v242, v164, v165
    v_cvt_pk_bf16_f32 v243, v166, v167
    buffer_store_dwordx4 v[240:243], v26, s[36:39], 0 offen
TAILEND:
    s_waitcnt vmcnt(0)
    s_waitcnt vmcnt(0)
END:
    s_endpgm
SLOWS1:
    s_call_b64 s[6:7], SLOW
    s_branch SLOWR1
SLOWS2:
    s_call_b64 s[6:7], SLOW
    s_branch SLOWR2
SLOWS3:
    s_call_b64 s[6:7], SLOW
    s_branch SLOWR3
SLOWS4:
    s_call_b64 s[6:7], SLOW
    s_branch SLOWR4
SLOWS5:
    s_call_b64 s[6:7], SLOW
    s_branch SLOWR5
SLOWS6:
    s_call_b64 s[6:7], SLOW
    s_branch SLOWR6
SLOWS7:
    s_call_b64 s[6:7], SLOW
    s_branch SLOWR7
SLOWS8:
    s_call_b64 s[6:7], SLOW
    s_branch SLOWR8
SLOWS9:
    s_call_b64 s[6:7], SLOW
    s_branch SLOWR9
SLOWS10:
    s_call_b64 s[6:7], SLOW
    s_branch SLOWR10
SLOWS11:
    s_call_b64 s[6:7], SLOW
    s_branch SLOWR11
SLOWS12:
    s_call_b64 s[6:7], SLOW
    s_branch SLOWR12
SLOWS13:
    s_call_b64 s[6:7], SLOW
    s_branch SLOWR13
SLOWS14:
    s_call_b64 s[6:7], SLOW
    s_branch SLOWR14
SLOWS15:
    s_call_b64 s[6:7], SLOW
    s_branch SLOWR15
SLOW:
    v_mfma_f32_32x32x16_bf16 v[128:143], v[192:195], v[96:99], v[144:159]
    v_mfma_f32_32x32x16_bf16 v[128:143], v[196:199], v[100:103], v[128:143]
    v_mfma_f32_32x32x16_bf16 v[128:143], v[200:203], v[104:107], v[128:143]
    v_mfma_f32_32x32x16_bf16 v[128:143], v[204:207], v[108:111], v[128:143]
    v_mfma_f32_32x32x16_bf16 v[128:143], v[208:211], v[112:115], v[128:143]
    v_mfma_f32_32x32x16_bf16 v[128:143], v[212:215], v[116:119], v[128:143]
    v_mfma_f32_32x32x16_bf16 v[128:143], v[216:219], v[120:123], v[128:143]
    v_mfma_f32_32x32x16_bf16 v[128:143], v[220:223], v[124:127], v[128:143]
    s_nop 11
    v_max3_f32 v14, v128, v129, v130
    v_max3_f32 v15, v131, v132, v133
    v_max3_f32 v14, v14, v134, v135
    v_max3_f32 v15, v15, v136, v137
    v_max3_f32 v14, v14, v138, v139
    v_max3_f32 v15, v15, v140, v141
    v_max3_f32 v14, v14, v142, v143
    v_max_f32 v14, v14, v15
    v_mov_b32 v15, v14
    s_nop 1
    v_permlane32_swap_b32 v14, v15
    s_nop 1
    v_max_f32 v14, v14, v15
    v_max_f32 v14, 0, v14
    v_exp_f32 v31, -v14
    v_sub_f32 v128, v128, v14
    v_sub_f32 v129, v129, v14
    v_sub_f32 v130, v130, v14
    v_sub_f32 v131, v131, v14
    v_sub_f32 v132, v132, v14
    v_sub_f32 v133, v133, v14
    v_sub_f32 v134, v134, v14
    v_sub_f32 v135, v135, v14
    v_sub_f32 v136, v136, v14
    v_sub_f32 v137, v137, v14
    v_sub_f32 v138, v138, v14
    v_sub_f32 v139, v139, v14
    v_sub_f32 v140, v140, v14
    v_sub_f32 v141, v141, v14
    v_sub_f32 v142, v142, v14
    v_sub_f32 v143, v143, v14
    v_sub_f32 v144, v144, v14
    v_sub_f32 v145, v145, v14
    v_sub_f32 v146, v146, v14
    v_sub_f32 v147, v147, v14
    v_sub_f32 v148, v148, v14
    v_sub_f32 v149, v149, v14
    v_sub_f32 v150, v150, v14
    v_sub_f32 v151, v151, v14
    v_sub_f32 v152, v152, v14
    v_sub_f32 v153, v153, v14
    v_sub_f32 v154, v154, v14
    v_sub_f32 v155, v155, v14
    v_sub_f32 v156, v156, v14
    v_sub_f32 v157, v157, v14
    v_sub_f32 v158, v158, v14
    v_sub_f32 v159, v159, v14
    v_mul_f32 v13, v13, v31
    v_mul_f32 v32, v32, v31
    v_mul_f32 v33, v33, v31
    v_mul_f32 v34, v34, v31
    v_mul_f32 v35, v35, v31
    v_mul_f32 v36, v36, v31
    v_mul_f32 v37, v37, v31
    v_mul_f32 v38, v38, v31
    v_mul_f32 v39, v39, v31
    v_mul_f32 v40, v40, v31
    v_mul_f32 v41, v41, v31
    v_mul_f32 v42, v42, v31
    v_mul_f32 v43, v43, v31
    v_mul_f32 v44, v44, v31
    v_mul_f32 v45, v45, v31
    v_mul_f32 v46, v46, v31
    v_mul_f32 v47, v47, v31
    v_mul_f32 v48, v48, v31
    v_mul_f32 v49, v49, v31
    v_mul_f32 v50, v50, v31
    v_mul_f32 v51, v51, v31
    v_mul_f32 v52, v52, v31
    v_mul_f32 v53, v53, v31
    v_mul_f32 v54, v54, v31
    v_mul_f32 v55, v55, v31
    v_mul_f32 v56, v56, v31
    v_mul_f32 v57, v57, v31
    v_mul_f32 v58, v58, v31
    v_mul_f32 v59, v59, v31
    v_mul_f32 v60, v60, v31
    v_mul_f32 v61, v61, v31
    v_mul_f32 v62, v62, v31
    v_mul_f32 v63, v63, v31
    v_mul_f32 v64, v64, v31
    v_mul_f32 v65, v65, v31
    v_mul_f32 v66, v66, v31
    v_mul_f32 v67, v67, v31
    v_mul_f32 v68, v68, v31
    v_mul_f32 v69, v69, v31
    v_mul_f32 v70, v70, v31
    v_mul_f32 v71, v71, v31
    v_mul_f32 v72, v72, v31
    v_mul_f32 v73, v73, v31
    v_mul_f32 v74, v74, v31
    v_mul_f32 v75, v75, v31
    v_mul_f32 v76, v76, v31
    v_mul_f32 v77, v77, v31
    v_mul_f32 v78, v78, v31
    v_mul_f32 v79, v79, v31
    v_mul_f32 v80, v80, v31
    v_mul_f32 v81, v81, v31
    v_mul_f32 v82, v82, v31
    v_mul_f32 v83, v83, v31
    v_mul_f32 v84, v84, v31
    v_mul_f32 v85, v85, v31
    v_mul_f32 v86, v86, v31
    v_mul_f32 v87, v87, v31
    v_mul_f32 v88, v88, v31
    v_mul_f32 v89, v89, v31
    v_mul_f32 v90, v90, v31
    v_mul_f32 v91, v91, v31
    v_mul_f32 v92, v92, v31
    v_mul_f32 v93, v93, v31
    v_mul_f32 v94, v94, v31
    v_mul_f32 v95, v95, v31
    v_exp_f32 v128, v128
    v_exp_f32 v129, v129
    v_exp_f32 v130, v130
    v_exp_f32 v131, v131
    v_add_f32 v15, v128, v129
    v_exp_f32 v132, v132
    v_add_f32 v31, v130, v131
    v_exp_f32 v133, v133
    v_add_f32 v15, v15, v132
    v_exp_f32 v134, v134
    v_add_f32 v31, v31, v133
    v_exp_f32 v135, v135
    v_add_f32 v15, v15, v134
    v_exp_f32 v136, v136
    v_add_f32 v31, v31, v135
    v_exp_f32 v137, v137
    v_add_f32 v15, v15, v136
    v_exp_f32 v138, v138
    v_add_f32 v31, v31, v137
    v_exp_f32 v139, v139
    v_add_f32 v15, v15, v138
    v_exp_f32 v140, v140
    v_add_f32 v31, v31, v139
    v_exp_f32 v141, v141
    v_add_f32 v15, v15, v140
    v_exp_f32 v142, v142
    v_add_f32 v31, v31, v141
    v_exp_f32 v143, v143
    v_add_f32 v15, v15, v142
    v_add_f32 v15, v15, v31
    v_add_f32 v15, v15, v143
    s_nop 1
    s_setpc_b64 s[6:7]
.section .rodata,"a"
.p2align 6
.amdhsa_kernel concat_heads__gqa_block_cached__gqa_block_cached__near_ridge_kernel
  .amdhsa_next_free_vgpr 256
  .amdhsa_next_free_sgpr 102
  .amdhsa_accum_offset 256
  .amdhsa_group_segment_fixed_size 0
  .amdhsa_kernarg_size 104
  .amdhsa_user_sgpr_count 2
  .amdhsa_user_sgpr_kernarg_segment_ptr 1
  .amdhsa_system_sgpr_workgroup_id_x 1
.end_amdhsa_kernel
```
